```python
import torch

def _softmax(x, axis=-1):
    return torch.softmax(x, dim=axis)
def _gelu(x):
    return torch.nn.functional.gelu(x, approximate="tanh")
def _silu(x):
    return torch.nn.functional.silu(x)
def _sigmoid(x):
    return torch.sigmoid(x)
def _layernorm(x, axis=-1, eps=1e-5):
    m = x.mean(dim=axis, keepdim=True)
    v = x.var(dim=axis, keepdim=True, unbiased=False)
    return (x - m) / torch.sqrt(v + eps)
def _scatter_add(tgt, idx, src, axis=0):
    return tgt.clone().index_add_(axis, idx, src)
def _segment_sum(src, seg, n):
    out = torch.zeros((n,) + src.shape[1:], dtype=src.dtype)
    return out.index_add_(0, seg, src)
def _pad(x, pw):
    flat = tuple(v for pair in reversed(pw) for v in pair)
    return torch.nn.functional.pad(x, flat)

kernel_name = 'parallel_sum__ssm_conv_h3__mixer_token_mlp__prompt'

def setup_inputs():

    _w = (lambda a: (lambda t: t.to(torch.bfloat16) if t.is_floating_point() else t)(torch.as_tensor(a)))
    def _A_setup():
        B, S, D = 1, 2048, 640
        ks = 4
        return {
            "q": _w((lambda *s: torch.randn(*s, dtype=torch.bfloat16) * 0.05)(B, S, D)),
            "k": _w((lambda *s: torch.randn(*s, dtype=torch.bfloat16) * 0.2)(B, S, D)),
            "v": _w((lambda *s: torch.randn(*s, dtype=torch.bfloat16) * 0.2)(B, S, D)),
            "shift_k": _w((lambda *s: torch.randn(*s, dtype=torch.bfloat16) * 0.2)(D, ks) * 0.5),
            "ssm_k": _w((lambda *s: torch.randn(*s, dtype=torch.bfloat16) * 0.2)(D, S) * (1.0 / S ** 0.5)),
            "ssm_D": _w((lambda *s: torch.randn(*s, dtype=torch.bfloat16) * 0.2)(D)),
        }
    _A_in = _A_setup()

    def _B_setup():
        B, S, D, F = 1, 2048, 640, 1536
        return {
            "x": _w((lambda *s: torch.randn(*s, dtype=torch.bfloat16) * 0.05)(B, S, D)),
            "w1": _w((lambda *s: torch.randn(*s, dtype=torch.bfloat16) * 0.4)(S, F) * (S ** -0.5)),
            "b1": _w((lambda *s: torch.randn(*s, dtype=torch.bfloat16) * 3.2)(F) * 0.02),
            "w2": _w((lambda *s: torch.randn(*s, dtype=torch.bfloat16) * 0.1)(F, S) * (F ** -0.5)),
            "b2": _w((lambda *s: torch.randn(*s, dtype=torch.bfloat16) * 0.4)(S) * 0.02),
        }
    _B_in = _B_setup()

    return {
        "A_q": _A_in["q"],
        "A_k": _A_in["k"],
        "A_v": _A_in["v"],
        "A_shift_k": _A_in["shift_k"],
        "A_ssm_k": _A_in["ssm_k"],
        "A_ssm_D": _A_in["ssm_D"],
        "B_x": _B_in["x"],
        "B_w1": _B_in["w1"],
        "B_b1": _B_in["b1"],
        "B_w2": _B_in["w2"],
        "B_b2": _B_in["b2"],
    }

def reference(A_q, A_k, A_v, A_shift_k, A_ssm_k, A_ssm_D, B_x, B_w1, B_b1, B_w2, B_b2):
    def _A_ref(q, k, v, shift_k, ssm_k, ssm_D):
        B, S, D = q.shape
        ks = shift_k.shape[-1]
        k_pad = _pad(k, ((0, 0), (ks - 1, 0), (0, 0)))
        k_shift = torch.zeros_like(k)
        for t in range(ks):
            k_shift = k_shift + k_pad[:, t:t + S, :] * shift_k[:, ks - 1 - t][None, None, :]
        kv = k_shift * v
        L = 2 * S
        kv_pad = _pad(kv, ((0, 0), (0, S), (0, 0)))
        kf_pad = _pad(ssm_k, ((0, 0), (0, S)))
        kv_f = (lambda x, axes=(-2,-1): torch.fft.rfft2(x.float(), dim=axes))(kv_pad[:, None, :, :], axes=(1, 2))
        kf_f = (lambda x, axes=(-2,-1): torch.fft.rfft2(x.float(), dim=axes))(kf_pad[:, None, :], axes=(1, 2))
        kf_f = (lambda x, *d: x.permute(*d))(kf_f, 1, 2, 0)
        y_f = kv_f * kf_f[None, :, :, :]
        y = (lambda x, s, axes=(-2,-1): torch.fft.irfft2(x, s=s, dim=axes).to(torch.bfloat16))(y_f, (1, L), axes=(1, 2))[:, 0, :S, :]
        y = y + kv * ssm_D[None, None, :]
        return q * y

    def _B_ref(x, w1, b1, w2, b2):
        B, S, D = x.shape
        h = _layernorm(x, axis=-1)
        u = torch.einsum("bsd,sf->bdf", h, w1) + b1
        u = _gelu(u)
        y = torch.einsum("bdf,fs->bds", u, w2) + b2
        return (lambda x, *d: x.permute(*d))(y, 0, 2, 1)

    x = A_q
    xn = _layernorm(x, axis=-1)
    return x + _A_ref(xn, A_k, A_v, A_shift_k, A_ssm_k, A_ssm_D) + _B_ref(xn, B_w1, B_b1, B_w2, B_b2)
```

```asm
; @launch grid=(256,1,1) block=(512,1,1) lds=163840
.amdgcn_target "amdgcn-amd-amdhsa--gfx950"
.text
.globl parallel_sum__ssm_conv_h3__mixer_token_mlp__prompt_kernel
.p2align 8
.type parallel_sum__ssm_conv_h3__mixer_token_mlp__prompt_kernel,@function
parallel_sum__ssm_conv_h3__mixer_token_mlp__prompt_kernel:
    s_cmp_ge_u32 s2, 256
    s_cbranch_scc1 PK_END
    s_load_dwordx8 s[4:11], s[0:1], 0
    s_load_dwordx2 s[26:27], s[0:1], 104
    s_load_dwordx8 s[16:23], s[0:1], 56
    s_load_dwordx4 s[12:15], s[0:1], 32
    s_load_dwordx2 s[24:25], s[0:1], 88
    v_lshrrev_b32 v2, 6, v0
    v_and_b32 v1, 63, v0
    v_readfirstlane_b32 s101, v2
    v_lshlrev_b32 v3, 2, v1
    v_and_b32 v4, 124, v3
    v_add_u32 v4, 163712, v4
    v_mov_b32 v5, 0
    ds_write_b32 v4, v5
    s_and_b32 s3, s101, 3
    s_and_b32 s90, s2, 7
    s_lshr_b32 s91, s2, 3
    s_and_b32 s92, s90, 1
    s_lshl_b32 s83, s92, 2
    s_and_b32 s93, s91, 3
    s_add_u32 s83, s83, s93
    s_lshr_b32 s90, s90, 1
    s_lshl_b32 s84, s90, 3
    s_lshr_b32 s93, s91, 2
    s_add_u32 s84, s84, s93
    v_mov_b32 v8, 9846784
    s_cmp_lt_u32 s101, 4
    s_cbranch_scc1 PK_G
    s_setprio 3
    s_lshl_b32 s90, s2, 2
    s_add_u32 s90, s90, s3
    s_mul_i32 s101, s90, 2560
    s_waitcnt lgkmcnt(0)
    s_mov_b32 s32, s4
    s_mov_b32 s33, s5
    s_mov_b32 s34, 2621440
    s_mov_b32 s35, 0x00020000
    buffer_load_dword v16, v3, s[32:35], s101 offen offset:0
    buffer_load_dword v17, v3, s[32:35], s101 offen offset:256
    buffer_load_dword v18, v3, s[32:35], s101 offen offset:512
    buffer_load_dword v19, v3, s[32:35], s101 offen offset:768
    buffer_load_dword v20, v3, s[32:35], s101 offen offset:1024
    buffer_load_dword v21, v3, s[32:35], s101 offen offset:1280
    buffer_load_dword v22, v3, s[32:35], s101 offen offset:1536
    buffer_load_dword v23, v3, s[32:35], s101 offen offset:1792
    buffer_load_dword v24, v3, s[32:35], s101 offen offset:2048
    buffer_load_dword v25, v3, s[32:35], s101 offen offset:2304
    s_barrier
    s_branch PK_H
PK_G:
    s_getpc_b64 s[28:29]
PK_PC:
    s_sub_u32 s28, s28, PK_PC-parallel_sum__ssm_conv_h3__mixer_token_mlp__prompt_kernel
    s_subb_u32 s29, s29, 0
    v_and_b32 v9, 7, v0
    s_andn2_b32 s93, s2, 7
    v_add_lshl_u32 v9, v9, s93, 7
    v_min_u32 v9, PK_END-parallel_sum__ssm_conv_h3__mixer_token_mlp__prompt_kernel, v9
    global_load_dword v127, v9, s[28:29]
    s_setprio 1
    s_mul_hi_u32 s82, s91, 0x33333334
    s_mul_i32 s93, s82, 5
    s_sub_u32 s81, s91, s93
    s_mul_i32 s100, s81, 13
    s_lshr_b32 s100, s100, 2
    s_mul_i32 s93, s92, 5
    s_add_u32 s81, s81, s93
    s_mul_i32 s93, s90, 6
    s_add_u32 s82, s82, s93
    s_mul_hi_u32 s82, s91, 0x1999999a
    s_mul_i32 s93, s82, 10
    s_sub_u32 s81, s91, s93
    s_and_b32 s93, s2, 7
    s_mul_i32 s93, s93, 3
    s_add_u32 s82, s82, s93
    s_mul_i32 s100, s81, 13
    s_lshr_b32 s100, s100, 3
    s_cmp_ge_u32 s91, 30
    s_cselect_b32 s96, 1073741824, 0
    s_mul_i32 s85, s3, 28672
    s_lshl_b32 s89, s3, 4
    s_mov_b32 s86, s100
    v_lshrrev_b32 v2, 3, v1
    v_mul_u32_u24 v4, 3072, v2
    v_bfe_u32 v2, v1, 4, 1
    v_lshlrev_b32 v2, 2, v2
    v_and_b32 v3, 7, v1
    v_xor_b32 v2, v2, v3
    v_lshl_add_u32 v4, v2, 4, v4
    s_lshl_b32 s91, s82, 7
    s_add_u32 s91, s91, s96
    v_add_u32 v4, s91, v4
    v_add_u32 v5, 23552, v4
    v_add_u32 v6, 47104, v4
    v_add_u32 v7, 70656, v4
    s_waitcnt lgkmcnt(0)
    s_mov_b32 s56, s16
    s_mov_b32 s57, s17
    s_mov_b32 s58, 6291456
    s_mov_b32 s59, 0x00020000
    s_barrier
    s_add_u32 s87, s89, s86
    s_mul_i32 s87, s87, 98304
    s_add_u32 m0, s85, 0
    s_add_u32 s86, s86, 1
    s_and_b32 s86, s86, 15
    buffer_load_dwordx4 v4, s[56:59], s87 offen offset:0 lds
    buffer_load_dwordx4 v5, s[56:59], s87 offen offset:1024 lds
    buffer_load_dwordx4 v6, s[56:59], s87 offen offset:2048 lds
    buffer_load_dwordx4 v7, s[56:59], s87 offen offset:3072 lds
    s_add_u32 s87, s89, s86
    s_mul_i32 s87, s87, 98304
    s_add_u32 m0, s85, 4096
    s_add_u32 s86, s86, 1
    s_and_b32 s86, s86, 15
    buffer_load_dwordx4 v4, s[56:59], s87 offen offset:0 lds
    buffer_load_dwordx4 v5, s[56:59], s87 offen offset:1024 lds
    buffer_load_dwordx4 v6, s[56:59], s87 offen offset:2048 lds
    buffer_load_dwordx4 v7, s[56:59], s87 offen offset:3072 lds
    s_mov_b32 s76, s26
    s_mov_b32 s77, s27
    s_mov_b32 s78, 10113024
    s_mov_b32 s79, 0x00020000
    buffer_load_dword v9, v8, s[76:79], 0 offen sc1
    s_mov_b32 s64, s20
    s_mov_b32 s65, s21
    s_mov_b32 s66, 6291456
    s_mov_b32 s67, 0x00020000
    s_mov_b32 s68, s22
    s_mov_b32 s69, s23
    s_mov_b32 s70, 4096
    s_mov_b32 s71, 0x00020000
    s_mov_b32 s72, s24
    s_mov_b32 s73, s25
    s_mov_b32 s74, 2621440
    s_mov_b32 s75, 0x00020000
    v_lshrrev_b32 v2, 5, v1
    v_lshlrev_b32 v10, 10, v2
    v_mul_u32_u24 v12, 10240, v2
    v_bfe_u32 v2, v1, 2, 2
    v_lshl_add_u32 v10, v2, 7, v10
    v_bfe_u32 v2, v1, 3, 1
    v_lshl_add_u32 v10, v2, 6, v10
    v_bfe_u32 v2, v1, 4, 1
    v_lshl_add_u32 v10, v2, 5, v10
    v_and_b32 v2, 3, v1
    v_lshl_add_u32 v10, v2, 3, v10
    v_add_u32 v10, s85, v10
    v_xor_b32 v11, 64, v10
    v_and_b32 v2, 31, v1
    v_lshl_add_u32 v12, v2, 4, v12
    s_lshl_b32 s90, s81, 10
    s_add_u32 s90, s90, s96
    v_add_u32 v12, s90, v12
    v_add_u32 v13, 20480, v12
    s_and_b32 s90, s81, 3
    s_lshl_b32 s90, s90, 12
    s_add_u32 s90, s90, 9850880
    v_lshl_add_u32 v14, v0, 4, s90
    s_and_b32 s94, s83, 3
    s_mul_i32 s94, s94, 3
    s_mul_i32 s95, s3, 12
    s_mov_b32 s98, 0xbdd2d3e8
    s_waitcnt vmcnt(5)
    ds_read_b64_tr_b16 a[0:1], v10 offset:0
    ds_read_b64_tr_b16 a[2:3], v10 offset:512
    ds_read_b64_tr_b16 a[4:5], v11 offset:0
    ds_read_b64_tr_b16 a[6:7], v11 offset:512
    ds_read_b64_tr_b16 a[8:9], v10 offset:2048
    ds_read_b64_tr_b16 a[10:11], v10 offset:2560
    ds_read_b64_tr_b16 a[12:13], v11 offset:2048
    ds_read_b64_tr_b16 a[14:15], v11 offset:2560
    s_add_u32 s87, s89, s86
    s_mul_i32 s87, s87, 98304
    s_add_u32 m0, s85, 8192
    s_add_u32 s86, s86, 1
    s_and_b32 s86, s86, 15
    buffer_load_dwordx4 v4, s[56:59], s87 offen offset:0 lds
    buffer_load_dwordx4 v5, s[56:59], s87 offen offset:1024 lds
    buffer_load_dwordx4 v6, s[56:59], s87 offen offset:2048 lds
    buffer_load_dwordx4 v7, s[56:59], s87 offen offset:3072 lds
    s_waitcnt vmcnt(5)
    ds_read_b64_tr_b16 a[16:17], v10 offset:4096
    ds_read_b64_tr_b16 a[18:19], v10 offset:4608
    ds_read_b64_tr_b16 a[20:21], v11 offset:4096
    ds_read_b64_tr_b16 a[22:23], v11 offset:4608
    ds_read_b64_tr_b16 a[24:25], v10 offset:6144
    ds_read_b64_tr_b16 a[26:27], v10 offset:6656
    ds_read_b64_tr_b16 a[28:29], v11 offset:6144
    ds_read_b64_tr_b16 a[30:31], v11 offset:6656
    s_add_u32 s87, s89, s86
    s_mul_i32 s87, s87, 98304
    s_add_u32 m0, s85, 12288
    s_add_u32 s86, s86, 1
    s_and_b32 s86, s86, 15
    buffer_load_dwordx4 v4, s[56:59], s87 offen offset:0 lds
    buffer_load_dwordx4 v5, s[56:59], s87 offen offset:1024 lds
    buffer_load_dwordx4 v6, s[56:59], s87 offen offset:2048 lds
    buffer_load_dwordx4 v7, s[56:59], s87 offen offset:3072 lds
    s_waitcnt vmcnt(4)
    ds_read_b64_tr_b16 a[32:33], v10 offset:8192
    ds_read_b64_tr_b16 a[34:35], v10 offset:8704
    ds_read_b64_tr_b16 a[36:37], v11 offset:8192
    ds_read_b64_tr_b16 a[38:39], v11 offset:8704
    ds_read_b64_tr_b16 a[40:41], v10 offset:10240
    ds_read_b64_tr_b16 a[42:43], v10 offset:10752
    ds_read_b64_tr_b16 a[44:45], v11 offset:10240
    ds_read_b64_tr_b16 a[46:47], v11 offset:10752
    s_add_u32 s87, s89, s86
    s_mul_i32 s87, s87, 98304
    s_add_u32 m0, s85, 16384
    s_add_u32 s86, s86, 1
    s_and_b32 s86, s86, 15
    buffer_load_dwordx4 v4, s[56:59], s87 offen offset:0 lds
    buffer_load_dwordx4 v5, s[56:59], s87 offen offset:1024 lds
    buffer_load_dwordx4 v6, s[56:59], s87 offen offset:2048 lds
    buffer_load_dwordx4 v7, s[56:59], s87 offen offset:3072 lds
    v_readfirstlane_b32 s80, v9
    s_nop 3
    s_mul_i32 s80, s80, 1664525
    s_add_u32 s80, s80, 1013904223
    v_mov_b32 v2, 163736
    v_mov_b32 v3, 1
    s_waitcnt lgkmcnt(0)
    s_mov_b64 exec, 1
    ds_add_u32 v2, v3
    s_mov_b64 exec, -1
    s_waitcnt vmcnt(4)
    ds_read_b64_tr_b16 a[48:49], v10 offset:12288
    ds_read_b64_tr_b16 a[50:51], v10 offset:12800
    ds_read_b64_tr_b16 a[52:53], v11 offset:12288
    ds_read_b64_tr_b16 a[54:55], v11 offset:12800
    ds_read_b64_tr_b16 a[56:57], v10 offset:14336
    ds_read_b64_tr_b16 a[58:59], v10 offset:14848
    ds_read_b64_tr_b16 a[60:61], v11 offset:14336
    ds_read_b64_tr_b16 a[62:63], v11 offset:14848
    s_add_u32 s87, s89, s86
    s_mul_i32 s87, s87, 98304
    s_add_u32 m0, s85, 20480
    s_add_u32 s86, s86, 1
    s_and_b32 s86, s86, 15
    buffer_load_dwordx4 v4, s[56:59], s87 offen offset:0 lds
    buffer_load_dwordx4 v5, s[56:59], s87 offen offset:1024 lds
    buffer_load_dwordx4 v6, s[56:59], s87 offen offset:2048 lds
    buffer_load_dwordx4 v7, s[56:59], s87 offen offset:3072 lds
    s_waitcnt vmcnt(4)
    ds_read_b64_tr_b16 a[64:65], v10 offset:16384
    ds_read_b64_tr_b16 a[66:67], v10 offset:16896
    ds_read_b64_tr_b16 a[68:69], v11 offset:16384
    ds_read_b64_tr_b16 a[70:71], v11 offset:16896
    ds_read_b64_tr_b16 a[72:73], v10 offset:18432
    ds_read_b64_tr_b16 a[74:75], v10 offset:18944
    ds_read_b64_tr_b16 a[76:77], v11 offset:18432
    ds_read_b64_tr_b16 a[78:79], v11 offset:18944
    s_add_u32 s87, s89, s86
    s_mul_i32 s87, s87, 98304
    s_add_u32 m0, s85, 24576
    s_add_u32 s86, s86, 1
    s_and_b32 s86, s86, 15
    buffer_load_dwordx4 v4, s[56:59], s87 offen offset:0 lds
    buffer_load_dwordx4 v5, s[56:59], s87 offen offset:1024 lds
    buffer_load_dwordx4 v6, s[56:59], s87 offen offset:2048 lds
    buffer_load_dwordx4 v7, s[56:59], s87 offen offset:3072 lds
    s_waitcnt vmcnt(4)
    ds_read_b64_tr_b16 a[80:81], v10 offset:20480
    ds_read_b64_tr_b16 a[82:83], v10 offset:20992
    ds_read_b64_tr_b16 a[84:85], v11 offset:20480
    ds_read_b64_tr_b16 a[86:87], v11 offset:20992
    ds_read_b64_tr_b16 a[88:89], v10 offset:22528
    ds_read_b64_tr_b16 a[90:91], v10 offset:23040
    ds_read_b64_tr_b16 a[92:93], v11 offset:22528
    ds_read_b64_tr_b16 a[94:95], v11 offset:23040
    s_waitcnt lgkmcnt(8)
    s_add_u32 s87, s89, s86
    s_mul_i32 s87, s87, 98304
    s_add_u32 m0, s85, 0
    s_add_u32 s86, s86, 1
    s_and_b32 s86, s86, 15
    buffer_load_dwordx4 v4, s[56:59], s87 offen offset:0 lds
    buffer_load_dwordx4 v5, s[56:59], s87 offen offset:1024 lds
    buffer_load_dwordx4 v6, s[56:59], s87 offen offset:2048 lds
    buffer_load_dwordx4 v7, s[56:59], s87 offen offset:3072 lds
    s_waitcnt vmcnt(4)
    ds_read_b64_tr_b16 a[96:97], v10 offset:24576
    ds_read_b64_tr_b16 a[98:99], v10 offset:25088
    ds_read_b64_tr_b16 a[100:101], v11 offset:24576
    ds_read_b64_tr_b16 a[102:103], v11 offset:25088
    ds_read_b64_tr_b16 a[104:105], v10 offset:26624
    ds_read_b64_tr_b16 a[106:107], v10 offset:27136
    ds_read_b64_tr_b16 a[108:109], v11 offset:26624
    ds_read_b64_tr_b16 a[110:111], v11 offset:27136
    s_waitcnt lgkmcnt(8)
    s_add_u32 s87, s89, s86
    s_mul_i32 s87, s87, 98304
    s_add_u32 m0, s85, 4096
    s_add_u32 s86, s86, 1
    s_and_b32 s86, s86, 15
    buffer_load_dwordx4 v4, s[56:59], s87 offen offset:0 lds
    buffer_load_dwordx4 v5, s[56:59], s87 offen offset:1024 lds
    buffer_load_dwordx4 v6, s[56:59], s87 offen offset:2048 lds
    buffer_load_dwordx4 v7, s[56:59], s87 offen offset:3072 lds
    s_waitcnt lgkmcnt(0)
    s_add_u32 s87, s89, s86
    s_mul_i32 s87, s87, 98304
    s_add_u32 m0, s85, 8192
    s_add_u32 s86, s86, 1
    s_and_b32 s86, s86, 15
    buffer_load_dwordx4 v4, s[56:59], s87 offen offset:0 lds
    buffer_load_dwordx4 v5, s[56:59], s87 offen offset:1024 lds
    buffer_load_dwordx4 v6, s[56:59], s87 offen offset:2048 lds
    buffer_load_dwordx4 v7, s[56:59], s87 offen offset:3072 lds
    s_add_u32 s87, s89, s86
    s_mul_i32 s87, s87, 98304
    s_add_u32 m0, s85, 12288
    s_add_u32 s86, s86, 1
    s_and_b32 s86, s86, 15
    buffer_load_dwordx4 v4, s[56:59], s87 offen offset:0 lds
    buffer_load_dwordx4 v5, s[56:59], s87 offen offset:1024 lds
    buffer_load_dwordx4 v6, s[56:59], s87 offen offset:2048 lds
    buffer_load_dwordx4 v7, s[56:59], s87 offen offset:3072 lds
    s_add_u32 s87, s89, s86
    s_mul_i32 s87, s87, 98304
    s_add_u32 m0, s85, 16384
    s_add_u32 s86, s86, 1
    s_and_b32 s86, s86, 15
    buffer_load_dwordx4 v4, s[56:59], s87 offen offset:0 lds
    buffer_load_dwordx4 v5, s[56:59], s87 offen offset:1024 lds
    buffer_load_dwordx4 v6, s[56:59], s87 offen offset:2048 lds
    buffer_load_dwordx4 v7, s[56:59], s87 offen offset:3072 lds
    s_add_u32 s87, s89, s86
    s_mul_i32 s87, s87, 98304
    s_add_u32 m0, s85, 20480
    s_add_u32 s86, s86, 1
    s_and_b32 s86, s86, 15
    buffer_load_dwordx4 v4, s[56:59], s87 offen offset:0 lds
    buffer_load_dwordx4 v5, s[56:59], s87 offen offset:1024 lds
    buffer_load_dwordx4 v6, s[56:59], s87 offen offset:2048 lds
    buffer_load_dwordx4 v7, s[56:59], s87 offen offset:3072 lds
    s_add_u32 s87, s89, s86
    s_mul_i32 s87, s87, 98304
    s_add_u32 m0, s85, 24576
    s_add_u32 s86, s86, 1
    s_and_b32 s86, s86, 15
    buffer_load_dwordx4 v4, s[56:59], s87 offen offset:0 lds
    buffer_load_dwordx4 v5, s[56:59], s87 offen offset:1024 lds
    buffer_load_dwordx4 v6, s[56:59], s87 offen offset:2048 lds
    buffer_load_dwordx4 v7, s[56:59], s87 offen offset:3072 lds
    buffer_load_dword v15, v14, s[76:79], 0 offen sc1
    v_mov_b32 v2, 163716
    s_mov_b32 s99, 0
PK_B1W:
    ds_read_b32 v3, v2
    s_add_u32 s99, s99, 1
    s_cmp_gt_u32 s99, 2097152
    s_waitcnt lgkmcnt(0)
    v_cmp_gt_u32 vcc, 4, v3
    s_cbranch_scc1 PK_B1W_OK
    s_cbranch_vccnz PK_B1W
PK_B1W_OK:
    s_waitcnt vmcnt(0)
    v_cmp_ne_u32 vcc, s80, v15
    s_cbranch_vccz PK_SPIN_H_OK
    s_mov_b32 s99, 0
PK_SPIN_H:
    s_sleep 4
    buffer_load_dword v15, v14, s[76:79], 0 offen sc1
    s_add_u32 s99, s99, 1
    s_waitcnt vmcnt(0)
    v_cmp_ne_u32 vcc, s80, v15
    s_cmp_gt_u32 s99, 20000
    s_cbranch_scc1 PK_SPIN_H_OK
    s_cbranch_vccnz PK_SPIN_H
PK_SPIN_H_OK:
    s_setprio 2
    s_mov_b32 s97, s100
    s_add_u32 s88, s89, s97
    s_mul_i32 s88, s88, 40960
    s_add_u32 s97, s97, 1
    s_and_b32 s97, s97, 15
    buffer_load_dwordx4 v[16:19], v12, s[76:79], s88 offen offset:0 sc1
    buffer_load_dwordx4 v[20:23], v12, s[76:79], s88 offen offset:512 sc1
    buffer_load_dwordx4 v[24:27], v13, s[76:79], s88 offen offset:0 sc1
    buffer_load_dwordx4 v[28:31], v13, s[76:79], s88 offen offset:512 sc1
    s_add_u32 s88, s89, s97
    s_mul_i32 s88, s88, 40960
    s_add_u32 s97, s97, 1
    s_and_b32 s97, s97, 15
    buffer_load_dwordx4 v[32:35], v12, s[76:79], s88 offen offset:0 sc1
    buffer_load_dwordx4 v[36:39], v12, s[76:79], s88 offen offset:512 sc1
    buffer_load_dwordx4 v[40:43], v13, s[76:79], s88 offen offset:0 sc1
    buffer_load_dwordx4 v[44:47], v13, s[76:79], s88 offen offset:512 sc1
    s_add_u32 s88, s89, s97
    s_mul_i32 s88, s88, 40960
    s_add_u32 s97, s97, 1
    s_and_b32 s97, s97, 15
    buffer_load_dwordx4 v[48:51], v12, s[76:79], s88 offen offset:0 sc1
    buffer_load_dwordx4 v[52:55], v12, s[76:79], s88 offen offset:512 sc1
    buffer_load_dwordx4 v[56:59], v13, s[76:79], s88 offen offset:0 sc1
    buffer_load_dwordx4 v[60:63], v13, s[76:79], s88 offen offset:512 sc1
    s_add_u32 s88, s89, s97
    s_mul_i32 s88, s88, 40960
    s_add_u32 s97, s97, 1
    s_and_b32 s97, s97, 15
    buffer_load_dwordx4 a[112:115], v12, s[76:79], s88 offen offset:0 sc1
    buffer_load_dwordx4 a[116:119], v12, s[76:79], s88 offen offset:512 sc1
    buffer_load_dwordx4 a[120:123], v13, s[76:79], s88 offen offset:0 sc1
    buffer_load_dwordx4 a[124:127], v13, s[76:79], s88 offen offset:512 sc1
    s_waitcnt lgkmcnt(0)
    s_add_u32 s88, s89, s97
    s_mul_i32 s88, s88, 40960
    s_add_u32 s97, s97, 1
    s_and_b32 s97, s97, 15
    s_waitcnt vmcnt(15)
    v_mfma_f32_32x32x16_bf16 v[64:79], a[0:3], v[16:19], 0
    v_mfma_f32_32x32x16_bf16 v[96:111], a[4:7], v[16:19], 0
    buffer_load_dwordx4 v[16:19], v12, s[76:79], s88 offen offset:0 sc1
    s_waitcnt vmcnt(15)
    v_mfma_f32_32x32x16_bf16 v[80:95], a[0:3], v[20:23], 0
    v_mfma_f32_32x32x16_bf16 v[112:127], a[4:7], v[20:23], 0
    buffer_load_dwordx4 v[20:23], v12, s[76:79], s88 offen offset:512 sc1
    s_waitcnt vmcnt(15)
    v_mfma_f32_32x32x16_bf16 v[64:79], a[8:11], v[24:27], v[64:79]
    v_mfma_f32_32x32x16_bf16 v[96:111], a[12:15], v[24:27], v[96:111]
    buffer_load_dwordx4 v[24:27], v13, s[76:79], s88 offen offset:0 sc1
    s_waitcnt vmcnt(15)
    v_mfma_f32_32x32x16_bf16 v[80:95], a[8:11], v[28:31], v[80:95]
    v_mfma_f32_32x32x16_bf16 v[112:127], a[12:15], v[28:31], v[112:127]
    buffer_load_dwordx4 v[28:31], v13, s[76:79], s88 offen offset:512 sc1
    s_add_u32 s88, s89, s97
    s_mul_i32 s88, s88, 40960
    s_add_u32 s97, s97, 1
    s_and_b32 s97, s97, 15
    s_waitcnt vmcnt(15)
    v_mfma_f32_32x32x16_bf16 v[64:79], a[16:19], v[32:35], v[64:79]
    ds_read_b64_tr_b16 a[0:1], v10 offset:0
    v_mfma_f32_32x32x16_bf16 v[96:111], a[20:23], v[32:35], v[96:111]
    ds_read_b64_tr_b16 a[2:3], v10 offset:512
    buffer_load_dwordx4 v[32:35], v12, s[76:79], s88 offen offset:0 sc1
    s_waitcnt vmcnt(15)
    v_mfma_f32_32x32x16_bf16 v[80:95], a[16:19], v[36:39], v[80:95]
    ds_read_b64_tr_b16 a[4:5], v11 offset:0
    v_mfma_f32_32x32x16_bf16 v[112:127], a[20:23], v[36:39], v[112:127]
    ds_read_b64_tr_b16 a[6:7], v11 offset:512
    buffer_load_dwordx4 v[36:39], v12, s[76:79], s88 offen offset:512 sc1
    s_waitcnt vmcnt(15)
    v_mfma_f32_32x32x16_bf16 v[64:79], a[24:27], v[40:43], v[64:79]
    ds_read_b64_tr_b16 a[8:9], v10 offset:2048
    v_mfma_f32_32x32x16_bf16 v[96:111], a[28:31], v[40:43], v[96:111]
    ds_read_b64_tr_b16 a[10:11], v10 offset:2560
    buffer_load_dwordx4 v[40:43], v13, s[76:79], s88 offen offset:0 sc1
    s_waitcnt vmcnt(15)
    v_mfma_f32_32x32x16_bf16 v[80:95], a[24:27], v[44:47], v[80:95]
    ds_read_b64_tr_b16 a[12:13], v11 offset:2048
    v_mfma_f32_32x32x16_bf16 v[112:127], a[28:31], v[44:47], v[112:127]
    ds_read_b64_tr_b16 a[14:15], v11 offset:2560
    buffer_load_dwordx4 v[44:47], v13, s[76:79], s88 offen offset:512 sc1
    s_add_u32 s88, s89, s97
    s_mul_i32 s88, s88, 40960
    s_add_u32 s97, s97, 1
    s_and_b32 s97, s97, 15
    s_waitcnt vmcnt(15)
    v_mfma_f32_32x32x16_bf16 v[64:79], a[32:35], v[48:51], v[64:79]
    ds_read_b64_tr_b16 a[16:17], v10 offset:4096
    v_mfma_f32_32x32x16_bf16 v[96:111], a[36:39], v[48:51], v[96:111]
    ds_read_b64_tr_b16 a[18:19], v10 offset:4608
    buffer_load_dwordx4 v[48:51], v12, s[76:79], s88 offen offset:0 sc1
    s_waitcnt vmcnt(15)
    v_mfma_f32_32x32x16_bf16 v[80:95], a[32:35], v[52:55], v[80:95]
    ds_read_b64_tr_b16 a[20:21], v11 offset:4096
    v_mfma_f32_32x32x16_bf16 v[112:127], a[36:39], v[52:55], v[112:127]
    ds_read_b64_tr_b16 a[22:23], v11 offset:4608
    buffer_load_dwordx4 v[52:55], v12, s[76:79], s88 offen offset:512 sc1
    s_waitcnt vmcnt(15)
    v_mfma_f32_32x32x16_bf16 v[64:79], a[40:43], v[56:59], v[64:79]
    ds_read_b64_tr_b16 a[24:25], v10 offset:6144
    v_mfma_f32_32x32x16_bf16 v[96:111], a[44:47], v[56:59], v[96:111]
    ds_read_b64_tr_b16 a[26:27], v10 offset:6656
    buffer_load_dwordx4 v[56:59], v13, s[76:79], s88 offen offset:0 sc1
    s_waitcnt vmcnt(15)
    v_mfma_f32_32x32x16_bf16 v[80:95], a[40:43], v[60:63], v[80:95]
    ds_read_b64_tr_b16 a[28:29], v11 offset:6144
    v_mfma_f32_32x32x16_bf16 v[112:127], a[44:47], v[60:63], v[112:127]
    ds_read_b64_tr_b16 a[30:31], v11 offset:6656
    buffer_load_dwordx4 v[60:63], v13, s[76:79], s88 offen offset:512 sc1
    s_add_u32 s88, s89, s97
    s_mul_i32 s88, s88, 40960
    s_add_u32 s97, s97, 1
    s_and_b32 s97, s97, 15
    s_waitcnt lgkmcnt(8)
    s_add_u32 s87, s89, s86
    s_mul_i32 s87, s87, 98304
    s_add_u32 m0, s85, 0
    s_add_u32 s86, s86, 1
    s_and_b32 s86, s86, 15
    buffer_load_dwordx4 v4, s[56:59], s87 offen offset:0 lds
    buffer_load_dwordx4 v5, s[56:59], s87 offen offset:1024 lds
    buffer_load_dwordx4 v6, s[56:59], s87 offen offset:2048 lds
    buffer_load_dwordx4 v7, s[56:59], s87 offen offset:3072 lds
    s_waitcnt vmcnt(19)
    v_mfma_f32_32x32x16_bf16 v[64:79], a[48:51], a[112:115], v[64:79]
    ds_read_b64_tr_b16 a[32:33], v10 offset:8192
    v_mfma_f32_32x32x16_bf16 v[96:111], a[52:55], a[112:115], v[96:111]
    ds_read_b64_tr_b16 a[34:35], v10 offset:8704
    buffer_load_dwordx4 a[112:115], v12, s[76:79], s88 offen offset:0 sc1
    s_waitcnt vmcnt(19)
    v_mfma_f32_32x32x16_bf16 v[80:95], a[48:51], a[116:119], v[80:95]
    ds_read_b64_tr_b16 a[36:37], v11 offset:8192
    v_mfma_f32_32x32x16_bf16 v[112:127], a[52:55], a[116:119], v[112:127]
    ds_read_b64_tr_b16 a[38:39], v11 offset:8704
    buffer_load_dwordx4 a[116:119], v12, s[76:79], s88 offen offset:512 sc1
    s_waitcnt vmcnt(19)
    v_mfma_f32_32x32x16_bf16 v[64:79], a[56:59], a[120:123], v[64:79]
    ds_read_b64_tr_b16 a[40:41], v10 offset:10240
    v_mfma_f32_32x32x16_bf16 v[96:111], a[60:63], a[120:123], v[96:111]
    ds_read_b64_tr_b16 a[42:43], v10 offset:10752
    buffer_load_dwordx4 a[120:123], v13, s[76:79], s88 offen offset:0 sc1
    s_waitcnt vmcnt(19)
    v_mfma_f32_32x32x16_bf16 v[80:95], a[56:59], a[124:127], v[80:95]
    ds_read_b64_tr_b16 a[44:45], v11 offset:10240
    v_mfma_f32_32x32x16_bf16 v[112:127], a[60:63], a[124:127], v[112:127]
    ds_read_b64_tr_b16 a[46:47], v11 offset:10752
    buffer_load_dwordx4 a[124:127], v13, s[76:79], s88 offen offset:512 sc1
    s_add_u32 s88, s89, s97
    s_mul_i32 s88, s88, 40960
    s_add_u32 s97, s97, 1
    s_and_b32 s97, s97, 15
    s_waitcnt lgkmcnt(8)
    s_add_u32 s87, s89, s86
    s_mul_i32 s87, s87, 98304
    s_add_u32 m0, s85, 4096
    s_add_u32 s86, s86, 1
    s_and_b32 s86, s86, 15
    buffer_load_dwordx4 v4, s[56:59], s87 offen offset:0 lds
    buffer_load_dwordx4 v5, s[56:59], s87 offen offset:1024 lds
    buffer_load_dwordx4 v6, s[56:59], s87 offen offset:2048 lds
    buffer_load_dwordx4 v7, s[56:59], s87 offen offset:3072 lds
    s_waitcnt vmcnt(23)
    v_mfma_f32_32x32x16_bf16 v[64:79], a[64:67], v[16:19], v[64:79]
    ds_read_b64_tr_b16 a[48:49], v10 offset:12288
    v_mfma_f32_32x32x16_bf16 v[96:111], a[68:71], v[16:19], v[96:111]
    ds_read_b64_tr_b16 a[50:51], v10 offset:12800
    buffer_load_dwordx4 v[16:19], v12, s[76:79], s88 offen offset:0 sc1
    s_waitcnt vmcnt(23)
    v_mfma_f32_32x32x16_bf16 v[80:95], a[64:67], v[20:23], v[80:95]
    ds_read_b64_tr_b16 a[52:53], v11 offset:12288
    v_mfma_f32_32x32x16_bf16 v[112:127], a[68:71], v[20:23], v[112:127]
    ds_read_b64_tr_b16 a[54:55], v11 offset:12800
    buffer_load_dwordx4 v[20:23], v12, s[76:79], s88 offen offset:512 sc1
    s_waitcnt vmcnt(23)
    v_mfma_f32_32x32x16_bf16 v[64:79], a[72:75], v[24:27], v[64:79]
    ds_read_b64_tr_b16 a[56:57], v10 offset:14336
    v_mfma_f32_32x32x16_bf16 v[96:111], a[76:79], v[24:27], v[96:111]
    ds_read_b64_tr_b16 a[58:59], v10 offset:14848
    buffer_load_dwordx4 v[24:27], v13, s[76:79], s88 offen offset:0 sc1
    s_waitcnt vmcnt(23)
    v_mfma_f32_32x32x16_bf16 v[80:95], a[72:75], v[28:31], v[80:95]
    ds_read_b64_tr_b16 a[60:61], v11 offset:14336
    v_mfma_f32_32x32x16_bf16 v[112:127], a[76:79], v[28:31], v[112:127]
    ds_read_b64_tr_b16 a[62:63], v11 offset:14848
    buffer_load_dwordx4 v[28:31], v13, s[76:79], s88 offen offset:512 sc1
    s_add_u32 s88, s89, s97
    s_mul_i32 s88, s88, 40960
    s_add_u32 s97, s97, 1
    s_and_b32 s97, s97, 15
    s_waitcnt vmcnt(23)
    v_mfma_f32_32x32x16_bf16 v[64:79], a[80:83], v[32:35], v[64:79]
    ds_read_b64_tr_b16 a[64:65], v10 offset:16384
    v_mfma_f32_32x32x16_bf16 v[96:111], a[84:87], v[32:35], v[96:111]
    ds_read_b64_tr_b16 a[66:67], v10 offset:16896
    buffer_load_dwordx4 v[32:35], v12, s[76:79], s88 offen offset:0 sc1
    s_waitcnt vmcnt(23)
    v_mfma_f32_32x32x16_bf16 v[80:95], a[80:83], v[36:39], v[80:95]
    ds_read_b64_tr_b16 a[68:69], v11 offset:16384
    v_mfma_f32_32x32x16_bf16 v[112:127], a[84:87], v[36:39], v[112:127]
    ds_read_b64_tr_b16 a[70:71], v11 offset:16896
    buffer_load_dwordx4 v[36:39], v12, s[76:79], s88 offen offset:512 sc1
    s_waitcnt vmcnt(23)
    v_mfma_f32_32x32x16_bf16 v[64:79], a[88:91], v[40:43], v[64:79]
    ds_read_b64_tr_b16 a[72:73], v10 offset:18432
    v_mfma_f32_32x32x16_bf16 v[96:111], a[92:95], v[40:43], v[96:111]
    ds_read_b64_tr_b16 a[74:75], v10 offset:18944
    buffer_load_dwordx4 v[40:43], v13, s[76:79], s88 offen offset:0 sc1
    s_waitcnt vmcnt(23)
    v_mfma_f32_32x32x16_bf16 v[80:95], a[88:91], v[44:47], v[80:95]
    ds_read_b64_tr_b16 a[76:77], v11 offset:18432
    v_mfma_f32_32x32x16_bf16 v[112:127], a[92:95], v[44:47], v[112:127]
    ds_read_b64_tr_b16 a[78:79], v11 offset:18944
    buffer_load_dwordx4 v[44:47], v13, s[76:79], s88 offen offset:512 sc1
    s_add_u32 s88, s89, s97
    s_mul_i32 s88, s88, 40960
    s_add_u32 s97, s97, 1
    s_and_b32 s97, s97, 15
    s_waitcnt vmcnt(23)
    v_mfma_f32_32x32x16_bf16 v[64:79], a[96:99], v[48:51], v[64:79]
    ds_read_b64_tr_b16 a[80:81], v10 offset:20480
    v_mfma_f32_32x32x16_bf16 v[96:111], a[100:103], v[48:51], v[96:111]
    ds_read_b64_tr_b16 a[82:83], v10 offset:20992
    buffer_load_dwordx4 v[48:51], v12, s[76:79], s88 offen offset:0 sc1
    s_waitcnt vmcnt(23)
    v_mfma_f32_32x32x16_bf16 v[80:95], a[96:99], v[52:55], v[80:95]
    ds_read_b64_tr_b16 a[84:85], v11 offset:20480
    v_mfma_f32_32x32x16_bf16 v[112:127], a[100:103], v[52:55], v[112:127]
    ds_read_b64_tr_b16 a[86:87], v11 offset:20992
    buffer_load_dwordx4 v[52:55], v12, s[76:79], s88 offen offset:512 sc1
    s_waitcnt vmcnt(23)
    v_mfma_f32_32x32x16_bf16 v[64:79], a[104:107], v[56:59], v[64:79]
    ds_read_b64_tr_b16 a[88:89], v10 offset:22528
    v_mfma_f32_32x32x16_bf16 v[96:111], a[108:111], v[56:59], v[96:111]
    ds_read_b64_tr_b16 a[90:91], v10 offset:23040
    buffer_load_dwordx4 v[56:59], v13, s[76:79], s88 offen offset:0 sc1
    s_waitcnt vmcnt(23)
    v_mfma_f32_32x32x16_bf16 v[80:95], a[104:107], v[60:63], v[80:95]
    ds_read_b64_tr_b16 a[92:93], v11 offset:22528
    v_mfma_f32_32x32x16_bf16 v[112:127], a[108:111], v[60:63], v[112:127]
    ds_read_b64_tr_b16 a[94:95], v11 offset:23040
    buffer_load_dwordx4 v[60:63], v13, s[76:79], s88 offen offset:512 sc1
    s_add_u32 s88, s89, s97
    s_mul_i32 s88, s88, 40960
    s_add_u32 s97, s97, 1
    s_and_b32 s97, s97, 15
    s_waitcnt lgkmcnt(8)
    s_waitcnt vmcnt(19)
    v_mfma_f32_32x32x16_bf16 v[64:79], a[0:3], a[112:115], v[64:79]
    ds_read_b64_tr_b16 a[96:97], v10 offset:24576
    v_mfma_f32_32x32x16_bf16 v[96:111], a[4:7], a[112:115], v[96:111]
    ds_read_b64_tr_b16 a[98:99], v10 offset:25088
    buffer_load_dwordx4 a[112:115], v12, s[76:79], s88 offen offset:0 sc1
    s_waitcnt vmcnt(19)
    v_mfma_f32_32x32x16_bf16 v[80:95], a[0:3], a[116:119], v[80:95]
    ds_read_b64_tr_b16 a[100:101], v11 offset:24576
    v_mfma_f32_32x32x16_bf16 v[112:127], a[4:7], a[116:119], v[112:127]
    ds_read_b64_tr_b16 a[102:103], v11 offset:25088
    buffer_load_dwordx4 a[116:119], v12, s[76:79], s88 offen offset:512 sc1
    s_waitcnt vmcnt(19)
    v_mfma_f32_32x32x16_bf16 v[64:79], a[8:11], a[120:123], v[64:79]
    ds_read_b64_tr_b16 a[104:105], v10 offset:26624
    v_mfma_f32_32x32x16_bf16 v[96:111], a[12:15], a[120:123], v[96:111]
    ds_read_b64_tr_b16 a[106:107], v10 offset:27136
    buffer_load_dwordx4 a[120:123], v13, s[76:79], s88 offen offset:0 sc1
    s_waitcnt vmcnt(19)
    v_mfma_f32_32x32x16_bf16 v[80:95], a[8:11], a[124:127], v[80:95]
    ds_read_b64_tr_b16 a[108:109], v11 offset:26624
    v_mfma_f32_32x32x16_bf16 v[112:127], a[12:15], a[124:127], v[112:127]
    ds_read_b64_tr_b16 a[110:111], v11 offset:27136
    buffer_load_dwordx4 a[124:127], v13, s[76:79], s88 offen offset:512 sc1
    s_add_u32 s88, s89, s97
    s_mul_i32 s88, s88, 40960
    s_add_u32 s97, s97, 1
    s_and_b32 s97, s97, 15
    s_waitcnt lgkmcnt(8)
    s_waitcnt vmcnt(15)
    v_mfma_f32_32x32x16_bf16 v[64:79], a[16:19], v[16:19], v[64:79]
    ds_read_b64_tr_b16 a[0:1], v10 offset:0
    v_mfma_f32_32x32x16_bf16 v[96:111], a[20:23], v[16:19], v[96:111]
    ds_read_b64_tr_b16 a[2:3], v10 offset:512
    buffer_load_dwordx4 v[16:19], v12, s[76:79], s88 offen offset:0 sc1
    s_waitcnt vmcnt(15)
    v_mfma_f32_32x32x16_bf16 v[80:95], a[16:19], v[20:23], v[80:95]
    ds_read_b64_tr_b16 a[4:5], v11 offset:0
    v_mfma_f32_32x32x16_bf16 v[112:127], a[20:23], v[20:23], v[112:127]
    ds_read_b64_tr_b16 a[6:7], v11 offset:512
    buffer_load_dwordx4 v[20:23], v12, s[76:79], s88 offen offset:512 sc1
    s_waitcnt vmcnt(15)
    v_mfma_f32_32x32x16_bf16 v[64:79], a[24:27], v[24:27], v[64:79]
    ds_read_b64_tr_b16 a[8:9], v10 offset:2048
    v_mfma_f32_32x32x16_bf16 v[96:111], a[28:31], v[24:27], v[96:111]
    ds_read_b64_tr_b16 a[10:11], v10 offset:2560
    buffer_load_dwordx4 v[24:27], v13, s[76:79], s88 offen offset:0 sc1
    s_waitcnt vmcnt(15)
    v_mfma_f32_32x32x16_bf16 v[80:95], a[24:27], v[28:31], v[80:95]
    ds_read_b64_tr_b16 a[12:13], v11 offset:2048
    v_mfma_f32_32x32x16_bf16 v[112:127], a[28:31], v[28:31], v[112:127]
    ds_read_b64_tr_b16 a[14:15], v11 offset:2560
    buffer_load_dwordx4 v[28:31], v13, s[76:79], s88 offen offset:512 sc1
    s_add_u32 s88, s89, s97
    s_mul_i32 s88, s88, 40960
    s_add_u32 s97, s97, 1
    s_and_b32 s97, s97, 15
    s_waitcnt lgkmcnt(8)
    s_waitcnt vmcnt(15)
    v_mfma_f32_32x32x16_bf16 v[64:79], a[32:35], v[32:35], v[64:79]
    ds_read_b64_tr_b16 a[16:17], v10 offset:4096
    v_mfma_f32_32x32x16_bf16 v[96:111], a[36:39], v[32:35], v[96:111]
    ds_read_b64_tr_b16 a[18:19], v10 offset:4608
    buffer_load_dwordx4 v[32:35], v12, s[76:79], s88 offen offset:0 sc1
    s_waitcnt vmcnt(15)
    v_mfma_f32_32x32x16_bf16 v[80:95], a[32:35], v[36:39], v[80:95]
    ds_read_b64_tr_b16 a[20:21], v11 offset:4096
    v_mfma_f32_32x32x16_bf16 v[112:127], a[36:39], v[36:39], v[112:127]
    ds_read_b64_tr_b16 a[22:23], v11 offset:4608
    buffer_load_dwordx4 v[36:39], v12, s[76:79], s88 offen offset:512 sc1
    s_waitcnt vmcnt(15)
    v_mfma_f32_32x32x16_bf16 v[64:79], a[40:43], v[40:43], v[64:79]
    ds_read_b64_tr_b16 a[24:25], v10 offset:6144
    v_mfma_f32_32x32x16_bf16 v[96:111], a[44:47], v[40:43], v[96:111]
    ds_read_b64_tr_b16 a[26:27], v10 offset:6656
    buffer_load_dwordx4 v[40:43], v13, s[76:79], s88 offen offset:0 sc1
    s_waitcnt vmcnt(15)
    v_mfma_f32_32x32x16_bf16 v[80:95], a[40:43], v[44:47], v[80:95]
    ds_read_b64_tr_b16 a[28:29], v11 offset:6144
    v_mfma_f32_32x32x16_bf16 v[112:127], a[44:47], v[44:47], v[112:127]
    ds_read_b64_tr_b16 a[30:31], v11 offset:6656
    buffer_load_dwordx4 v[44:47], v13, s[76:79], s88 offen offset:512 sc1
    s_add_u32 s88, s89, s97
    s_mul_i32 s88, s88, 40960
    s_add_u32 s97, s97, 1
    s_and_b32 s97, s97, 15
    s_waitcnt lgkmcnt(8)
    s_waitcnt vmcnt(15)
    v_mfma_f32_32x32x16_bf16 v[64:79], a[48:51], v[48:51], v[64:79]
    v_mfma_f32_32x32x16_bf16 v[96:111], a[52:55], v[48:51], v[96:111]
    buffer_load_dwordx4 v[48:51], v12, s[76:79], s88 offen offset:0 sc1
    s_waitcnt vmcnt(15)
    v_mfma_f32_32x32x16_bf16 v[80:95], a[48:51], v[52:55], v[80:95]
    v_mfma_f32_32x32x16_bf16 v[112:127], a[52:55], v[52:55], v[112:127]
    buffer_load_dwordx4 v[52:55], v12, s[76:79], s88 offen offset:512 sc1
    s_waitcnt vmcnt(15)
    v_mfma_f32_32x32x16_bf16 v[64:79], a[56:59], v[56:59], v[64:79]
    v_mfma_f32_32x32x16_bf16 v[96:111], a[60:63], v[56:59], v[96:111]
    buffer_load_dwordx4 v[56:59], v13, s[76:79], s88 offen offset:0 sc1
    s_waitcnt vmcnt(15)
    v_mfma_f32_32x32x16_bf16 v[80:95], a[56:59], v[60:63], v[80:95]
    v_mfma_f32_32x32x16_bf16 v[112:127], a[60:63], v[60:63], v[112:127]
    buffer_load_dwordx4 v[60:63], v13, s[76:79], s88 offen offset:512 sc1
    s_add_u32 s88, s89, s97
    s_mul_i32 s88, s88, 40960
    s_add_u32 s97, s97, 1
    s_and_b32 s97, s97, 15
    s_waitcnt lgkmcnt(0)
    v_mov_b32 v2, 163752
    v_mov_b32 v3, 1
    s_waitcnt lgkmcnt(0)
    s_mov_b64 exec, 1
    ds_add_u32 v2, v3
    s_mov_b64 exec, -1
    s_waitcnt vmcnt(15)
    v_mfma_f32_32x32x16_bf16 v[64:79], a[64:67], a[112:115], v[64:79]
    v_mfma_f32_32x32x16_bf16 v[96:111], a[68:71], a[112:115], v[96:111]
    buffer_load_dwordx4 a[112:115], v12, s[76:79], s88 offen offset:0 sc1
    s_waitcnt vmcnt(15)
    v_mfma_f32_32x32x16_bf16 v[80:95], a[64:67], a[116:119], v[80:95]
    v_mfma_f32_32x32x16_bf16 v[112:127], a[68:71], a[116:119], v[112:127]
    buffer_load_dwordx4 a[116:119], v12, s[76:79], s88 offen offset:512 sc1
    s_waitcnt vmcnt(15)
    v_mfma_f32_32x32x16_bf16 v[64:79], a[72:75], a[120:123], v[64:79]
    v_mfma_f32_32x32x16_bf16 v[96:111], a[76:79], a[120:123], v[96:111]
    buffer_load_dwordx4 a[120:123], v13, s[76:79], s88 offen offset:0 sc1
    s_waitcnt vmcnt(15)
    v_mfma_f32_32x32x16_bf16 v[80:95], a[72:75], a[124:127], v[80:95]
    v_mfma_f32_32x32x16_bf16 v[112:127], a[76:79], a[124:127], v[112:127]
    buffer_load_dwordx4 a[124:127], v13, s[76:79], s88 offen offset:512 sc1
    s_waitcnt lgkmcnt(0)
    s_waitcnt vmcnt(15)
    v_mfma_f32_32x32x16_bf16 v[64:79], a[80:83], v[16:19], v[64:79]
    v_lshrrev_b32 v2, 3, v1
    v_lshlrev_b32 v4, 12, v2
    v_mfma_f32_32x32x16_bf16 v[96:111], a[84:87], v[16:19], v[96:111]
    v_bfe_u32 v2, v1, 4, 1
    v_lshlrev_b32 v2, 1, v2
    s_waitcnt vmcnt(14)
    v_mfma_f32_32x32x16_bf16 v[80:95], a[80:83], v[20:23], v[80:95]
    v_and_b32 v3, 7, v1
    v_mfma_f32_32x32x16_bf16 v[112:127], a[84:87], v[20:23], v[112:127]
    v_xor_b32 v2, v2, v3
    v_lshl_add_u32 v4, v2, 4, v4
    s_waitcnt vmcnt(13)
    v_mfma_f32_32x32x16_bf16 v[64:79], a[88:91], v[24:27], v[64:79]
    s_lshl_b32 s90, s84, 7
    v_add_u32 v4, s90, v4
    v_mfma_f32_32x32x16_bf16 v[96:111], a[92:95], v[24:27], v[96:111]
    v_xor_b32 v2, 64, v4
    s_waitcnt vmcnt(12)
    v_mfma_f32_32x32x16_bf16 v[80:95], a[88:91], v[28:31], v[80:95]
    v_add_u32 v5, 31744, v2
    v_add_u32 v6, 63488, v4
    v_mfma_f32_32x32x16_bf16 v[112:127], a[92:95], v[28:31], v[112:127]
    v_add_u32 v7, 95232, v2
    s_waitcnt lgkmcnt(0)
    s_waitcnt vmcnt(11)
    v_mfma_f32_32x32x16_bf16 v[64:79], a[96:99], v[32:35], v[64:79]
    s_add_u32 s92, s85, 12288
    v_lshl_add_u32 v9, v1, 4, s92
    s_lshl_b32 s92, s3, 12
    s_add_u32 s92, s92, 12288
    v_mfma_f32_32x32x16_bf16 v[96:111], a[100:103], v[32:35], v[96:111]
    v_lshl_add_u32 v10, v1, 4, s92
    v_add_u32 v11, 57344, v10
    s_lshr_b32 s90, s3, 1
    s_waitcnt vmcnt(10)
    v_mfma_f32_32x32x16_bf16 v[80:95], a[96:99], v[36:39], v[80:95]
    s_lshl_b32 s90, s90, 6
    s_add_u32 s90, s90, 153472
    v_lshrrev_b32 v8, 5, v1
    v_mfma_f32_32x32x16_bf16 v[112:127], a[100:103], v[36:39], v[112:127]
    v_lshl_add_u32 v8, v8, 3, s90
    s_lshr_b32 s90, s3, 1
    s_lshl_b32 s90, s90, 2
    s_waitcnt vmcnt(9)
    v_mfma_f32_32x32x16_bf16 v[64:79], a[104:107], v[40:43], v[64:79]
    s_lshl_b32 s91, s82, 3
    s_add_u32 s90, s90, s91
    s_mul_i32 s90, s90, 10240
    v_mfma_f32_32x32x16_bf16 v[96:111], a[108:111], v[40:43], v[96:111]
    s_and_b32 s91, s3, 1
    s_lshl_b32 s91, s91, 9
    s_add_u32 s90, s90, s91
    s_waitcnt vmcnt(8)
    v_mfma_f32_32x32x16_bf16 v[80:95], a[104:107], v[44:47], v[80:95]
    s_add_u32 s90, s90, 7843840
    v_add_u32 v14, s90, v13
    v_add_u32 v15, 20480, v14
    v_mfma_f32_32x32x16_bf16 v[112:127], a[108:111], v[44:47], v[112:127]
    v_mov_b32 v13, 0xc0135761
    s_mov_b32 s28, 1.0
    s_mov_b32 s29, 1.0
    s_waitcnt lgkmcnt(0)
    s_waitcnt vmcnt(7)
    v_mfma_f32_32x32x16_bf16 v[64:79], a[0:3], v[48:51], v[64:79]
    ds_read_b64 v[32:33], v8 offset:0
    v_mfma_f32_32x32x16_bf16 v[96:111], a[4:7], v[48:51], v[96:111]
    s_waitcnt vmcnt(6)
    v_mfma_f32_32x32x16_bf16 v[80:95], a[0:3], v[52:55], v[80:95]
    ds_read_b64 v[34:35], v8 offset:16
    v_mfma_f32_32x32x16_bf16 v[112:127], a[4:7], v[52:55], v[112:127]
    s_waitcnt vmcnt(5)
    v_mfma_f32_32x32x16_bf16 v[64:79], a[8:11], v[56:59], v[64:79]
    ds_read_b64 v[36:37], v8 offset:32
    v_mfma_f32_32x32x16_bf16 v[96:111], a[12:15], v[56:59], v[96:111]
    s_waitcnt vmcnt(4)
    v_mfma_f32_32x32x16_bf16 v[80:95], a[8:11], v[60:63], v[80:95]
    ds_read_b64 v[38:39], v8 offset:48
    v_mfma_f32_32x32x16_bf16 v[112:127], a[12:15], v[60:63], v[112:127]
    s_waitcnt lgkmcnt(0)
    s_waitcnt vmcnt(3)
    s_waitcnt vmcnt(2)
    s_waitcnt vmcnt(1)
    s_waitcnt vmcnt(0)
    v_mfma_f32_32x32x16_bf16 v[64:79], a[16:19], a[112:115], v[64:79]
    v_mfma_f32_32x32x16_bf16 v[64:79], a[24:27], a[120:123], v[64:79]
    v_mfma_f32_32x32x16_bf16 v[80:95], a[16:19], a[116:119], v[80:95]
    v_mfma_f32_32x32x16_bf16 v[80:95], a[24:27], a[124:127], v[80:95]
    s_waitcnt lgkmcnt(0)
    v_lshlrev_b32 v48, 16, v32
    v_and_b32 v49, 0xffff0000, v32
    v_lshlrev_b32 v50, 16, v33
    v_and_b32 v51, 0xffff0000, v33
    v_lshlrev_b32 v52, 16, v34
    v_and_b32 v53, 0xffff0000, v34
    v_lshlrev_b32 v54, 16, v35
    v_and_b32 v55, 0xffff0000, v35
    v_lshlrev_b32 v56, 16, v36
    v_and_b32 v57, 0xffff0000, v36
    ds_write_b128 v9, v[64:67] offset:0
    ds_write_b128 v9, v[68:71] offset:1024
    ds_write_b128 v9, v[72:75] offset:2048
    ds_write_b128 v9, v[76:79] offset:3072
    v_mfma_f32_32x32x16_bf16 v[96:111], a[20:23], a[112:115], v[96:111]
    v_mfma_f32_32x32x16_bf16 v[96:111], a[28:31], a[120:123], v[96:111]
    ds_write_b128 v9, v[80:83] offset:4096
    ds_write_b128 v9, v[84:87] offset:5120
    ds_write_b128 v9, v[88:91] offset:6144
    ds_write_b128 v9, v[92:95] offset:7168
    v_mfma_f32_32x32x16_bf16 v[112:127], a[20:23], a[116:119], v[112:127]
    v_mfma_f32_32x32x16_bf16 v[112:127], a[28:31], a[124:127], v[112:127]
    v_lshlrev_b32 v58, 16, v37
    v_and_b32 v59, 0xffff0000, v37
    v_lshlrev_b32 v60, 16, v38
    v_and_b32 v61, 0xffff0000, v38
    v_lshlrev_b32 v62, 16, v39
    v_and_b32 v63, 0xffff0000, v39
    ds_write_b128 v9, v[96:99] offset:8192
    ds_write_b128 v9, v[100:103] offset:9216
    ds_write_b128 v9, v[104:107] offset:10240
    ds_write_b128 v9, v[108:111] offset:11264
    s_nop 1
    ds_write_b128 v9, v[112:115] offset:12288
    ds_write_b128 v9, v[116:119] offset:13312
    ds_write_b128 v9, v[120:123] offset:14336
    ds_write_b128 v9, v[124:127] offset:15360
    v_mov_b32 v2, 163728
    v_mov_b32 v3, 1
    s_waitcnt lgkmcnt(0)
    s_mov_b64 exec, 1
    ds_add_u32 v2, v3
    s_mov_b64 exec, -1
    s_add_u32 s90, s94, 0
    s_sub_u32 s91, s90, 12
    s_min_u32 s90, s90, s91
    s_add_u32 s90, s90, s95
    s_add_u32 m0, s85, 0
    s_lshl_b32 s87, s90, 17
    buffer_load_dwordx4 v4, s[64:67], s87 offen offset:0 lds
    buffer_load_dwordx4 v5, s[64:67], s87 offen offset:1024 lds
    buffer_load_dwordx4 v6, s[64:67], s87 offen offset:2048 lds
    buffer_load_dwordx4 v7, s[64:67], s87 offen offset:3072 lds
    s_add_u32 s90, s94, 1
    s_sub_u32 s91, s90, 12
    s_min_u32 s90, s90, s91
    s_add_u32 s90, s90, s95
    s_add_u32 m0, s85, 4096
    s_lshl_b32 s87, s90, 17
    buffer_load_dwordx4 v4, s[64:67], s87 offen offset:0 lds
    buffer_load_dwordx4 v5, s[64:67], s87 offen offset:1024 lds
    buffer_load_dwordx4 v6, s[64:67], s87 offen offset:2048 lds
    buffer_load_dwordx4 v7, s[64:67], s87 offen offset:3072 lds
    v_mov_b32 v2, 163728
    s_mov_b32 s99, 0
PK_XW1:
    ds_read_b32 v3, v2
    s_add_u32 s99, s99, 1
    s_cmp_gt_u32 s99, 2097152
    s_waitcnt lgkmcnt(0)
    v_cmp_gt_u32 vcc, 4, v3
    s_cbranch_scc1 PK_XW1_OK
    s_cbranch_vccnz PK_XW1
PK_XW1_OK:
    ds_read_b128 v[64:67], v10 offset:0
    ds_read_b128 v[68:71], v10 offset:1024
    ds_read_b128 v[72:75], v10 offset:2048
    ds_read_b128 v[76:79], v10 offset:3072
    ds_read_b128 v[80:83], v10 offset:28672
    ds_read_b128 v[84:87], v10 offset:29696
    ds_read_b128 v[88:91], v10 offset:30720
    ds_read_b128 v[92:95], v10 offset:31744
    ds_read_b128 v[96:99], v11 offset:0
    ds_read_b128 v[100:103], v11 offset:1024
    ds_read_b128 v[104:107], v11 offset:2048
    ds_read_b128 v[108:111], v11 offset:3072
    ds_read_b128 v[112:115], v11 offset:28672
    ds_read_b128 v[116:119], v11 offset:29696
    ds_read_b128 v[120:123], v11 offset:30720
    ds_read_b128 v[124:127], v11 offset:31744
    s_waitcnt lgkmcnt(12)
    v_pk_add_f32 v[48:49], v[48:49], v[64:65]
    v_pk_add_f32 v[50:51], v[50:51], v[66:67]
    v_pk_add_f32 v[52:53], v[52:53], v[68:69]
    v_pk_add_f32 v[54:55], v[54:55], v[70:71]
    v_pk_add_f32 v[56:57], v[56:57], v[72:73]
    v_pk_add_f32 v[58:59], v[58:59], v[74:75]
    v_pk_add_f32 v[60:61], v[60:61], v[76:77]
    v_pk_add_f32 v[62:63], v[62:63], v[78:79]
    s_waitcnt lgkmcnt(8)
    v_pk_add_f32 v[48:49], v[48:49], v[80:81]
    v_pk_add_f32 v[50:51], v[50:51], v[82:83]
    v_pk_add_f32 v[52:53], v[52:53], v[84:85]
    v_pk_add_f32 v[54:55], v[54:55], v[86:87]
    v_pk_add_f32 v[56:57], v[56:57], v[88:89]
    v_pk_add_f32 v[58:59], v[58:59], v[90:91]
    v_pk_add_f32 v[60:61], v[60:61], v[92:93]
    v_pk_add_f32 v[62:63], v[62:63], v[94:95]
    s_waitcnt lgkmcnt(4)
    v_pk_add_f32 v[48:49], v[48:49], v[96:97]
    v_pk_add_f32 v[50:51], v[50:51], v[98:99]
    v_pk_add_f32 v[52:53], v[52:53], v[100:101]
    v_pk_add_f32 v[54:55], v[54:55], v[102:103]
    v_pk_add_f32 v[56:57], v[56:57], v[104:105]
    v_pk_add_f32 v[58:59], v[58:59], v[106:107]
    v_pk_add_f32 v[60:61], v[60:61], v[108:109]
    v_pk_add_f32 v[62:63], v[62:63], v[110:111]
    s_waitcnt lgkmcnt(0)
    v_pk_add_f32 v[48:49], v[48:49], v[112:113]
    v_pk_add_f32 v[50:51], v[50:51], v[114:115]
    v_pk_add_f32 v[52:53], v[52:53], v[116:117]
    v_pk_add_f32 v[54:55], v[54:55], v[118:119]
    v_pk_add_f32 v[56:57], v[56:57], v[120:121]
    v_pk_add_f32 v[58:59], v[58:59], v[122:123]
    v_pk_add_f32 v[60:61], v[60:61], v[124:125]
    v_pk_add_f32 v[62:63], v[62:63], v[126:127]
    v_mov_b32 v2, 163732
    v_mov_b32 v3, 1
    s_waitcnt lgkmcnt(0)
    s_mov_b64 exec, 1
    ds_add_u32 v2, v3
    s_mov_b64 exec, -1
    v_pk_mul_f32 v[64:65], v[48:49], v[48:49]
    v_pk_mul_f32 v[66:67], v[50:51], v[50:51]
    v_pk_mul_f32 v[68:69], v[52:53], v[52:53]
    v_pk_mul_f32 v[70:71], v[54:55], v[54:55]
    v_pk_mul_f32 v[72:73], v[56:57], v[56:57]
    v_pk_mul_f32 v[74:75], v[58:59], v[58:59]
    v_pk_mul_f32 v[76:77], v[60:61], v[60:61]
    v_pk_mul_f32 v[78:79], v[62:63], v[62:63]
    v_fma_f32 v64, v64, s98, v13
    v_fma_f32 v65, v65, s98, v13
    v_fma_f32 v66, v66, s98, v13
    v_fma_f32 v67, v67, s98, v13
    v_fma_f32 v68, v68, s98, v13
    v_fma_f32 v69, v69, s98, v13
    v_fma_f32 v70, v70, s98, v13
    v_fma_f32 v71, v71, s98, v13
    v_fma_f32 v72, v72, s98, v13
    v_fma_f32 v73, v73, s98, v13
    v_fma_f32 v74, v74, s98, v13
    v_fma_f32 v75, v75, s98, v13
    v_fma_f32 v76, v76, s98, v13
    v_fma_f32 v77, v77, s98, v13
    v_fma_f32 v78, v78, s98, v13
    v_fma_f32 v79, v79, s98, v13
    v_pk_mul_f32 v[64:65], v[64:65], v[48:49]
    v_pk_mul_f32 v[66:67], v[66:67], v[50:51]
    v_pk_mul_f32 v[68:69], v[68:69], v[52:53]
    v_pk_mul_f32 v[70:71], v[70:71], v[54:55]
    v_pk_mul_f32 v[72:73], v[72:73], v[56:57]
    v_pk_mul_f32 v[74:75], v[74:75], v[58:59]
    v_pk_mul_f32 v[76:77], v[76:77], v[60:61]
    v_pk_mul_f32 v[78:79], v[78:79], v[62:63]
    v_exp_f32 v64, v64
    v_exp_f32 v65, v65
    v_exp_f32 v66, v66
    v_exp_f32 v67, v67
    v_exp_f32 v68, v68
    v_exp_f32 v69, v69
    v_exp_f32 v70, v70
    v_exp_f32 v71, v71
    v_exp_f32 v72, v72
    v_exp_f32 v73, v73
    v_exp_f32 v74, v74
    v_exp_f32 v75, v75
    v_exp_f32 v76, v76
    v_exp_f32 v77, v77
    v_exp_f32 v78, v78
    v_exp_f32 v79, v79
    v_pk_add_f32 v[64:65], v[64:65], s[28:29]
    v_pk_add_f32 v[66:67], v[66:67], s[28:29]
    v_pk_add_f32 v[68:69], v[68:69], s[28:29]
    v_pk_add_f32 v[70:71], v[70:71], s[28:29]
    v_pk_add_f32 v[72:73], v[72:73], s[28:29]
    v_pk_add_f32 v[74:75], v[74:75], s[28:29]
    v_pk_add_f32 v[76:77], v[76:77], s[28:29]
    v_pk_add_f32 v[78:79], v[78:79], s[28:29]
    v_rcp_f32 v64, v64
    v_rcp_f32 v65, v65
    v_rcp_f32 v66, v66
    v_rcp_f32 v67, v67
    v_rcp_f32 v68, v68
    v_rcp_f32 v69, v69
    v_rcp_f32 v70, v70
    v_rcp_f32 v71, v71
    v_rcp_f32 v72, v72
    v_rcp_f32 v73, v73
    v_rcp_f32 v74, v74
    v_rcp_f32 v75, v75
    v_rcp_f32 v76, v76
    v_rcp_f32 v77, v77
    v_rcp_f32 v78, v78
    v_rcp_f32 v79, v79
    v_pk_mul_f32 v[48:49], v[48:49], v[64:65]
    v_pk_mul_f32 v[50:51], v[50:51], v[66:67]
    v_pk_mul_f32 v[52:53], v[52:53], v[68:69]
    v_pk_mul_f32 v[54:55], v[54:55], v[70:71]
    v_pk_mul_f32 v[56:57], v[56:57], v[72:73]
    v_pk_mul_f32 v[58:59], v[58:59], v[74:75]
    v_pk_mul_f32 v[60:61], v[60:61], v[76:77]
    v_pk_mul_f32 v[62:63], v[62:63], v[78:79]
    v_cvt_pk_bf16_f32 v80, v48, v49
    v_cvt_pk_bf16_f32 v81, v50, v51
    v_cvt_pk_bf16_f32 v82, v52, v53
    v_cvt_pk_bf16_f32 v83, v54, v55
    v_cvt_pk_bf16_f32 v84, v56, v57
    v_cvt_pk_bf16_f32 v85, v58, v59
    v_cvt_pk_bf16_f32 v86, v60, v61
    v_cvt_pk_bf16_f32 v87, v62, v63
    s_nop 1
    v_permlane32_swap_b32 v80, v82
    v_permlane32_swap_b32 v81, v83
    buffer_store_dwordx4 v[80:83], v14, s[76:79], 0 offen sc1
    v_permlane32_swap_b32 v84, v86
    v_permlane32_swap_b32 v85, v87
    buffer_store_dwordx4 v[84:87], v15, s[76:79], 0 offen sc1
PK_G_W2:
    v_mov_b32 v2, 163744
    v_mov_b32 v3, 1
    s_waitcnt lgkmcnt(0)
    s_mov_b64 exec, 1
    ds_add_u32 v2, v3
    s_mov_b64 exec, -1
    s_lshl_b32 s90, s81, 1
    s_and_b32 s91, s3, 1
    s_add_u32 s90, s90, s91
    s_mul_i32 s90, s90, 48
    s_lshl_b32 s91, s82, 1
    s_add_u32 s90, s90, s91
    s_lshr_b32 s91, s3, 1
    s_add_u32 s90, s90, s91
    s_lshl_b32 s90, s90, 4
    s_add_u32 s90, s90, 9981952
    s_add_u32 s101, s90, s96
    v_lshrrev_b32 v106, 4, v1
    v_and_b32 v107, 15, v1
    v_lshlrev_b32 v100, 10, v106
    v_bfe_u32 v2, v1, 2, 2
    v_lshl_add_u32 v100, v2, 7, v100
    v_bfe_u32 v2, v1, 3, 2
    v_lshl_add_u32 v100, v2, 5, v100
    v_and_b32 v2, 3, v1
    v_lshl_add_u32 v100, v2, 3, v100
    v_add_u32 v100, s85, v100
    v_xor_b32 v101, 32, v100
    v_xor_b32 v102, 64, v100
    v_xor_b32 v103, 96, v100
    v_min_u32 v2, 35, v1
    v_mul_u32_u24 v3, 43, v2
    v_lshrrev_b32 v3, 9, v3
    v_mul_u32_u24 v104, 36, v3
    v_add_u32 v104, v104, v2
    s_mul_i32 s93, s83, 80
    s_lshr_b32 s90, s93, 5
    s_mul_i32 s90, s90, 48
    s_add_u32 s90, s90, s95
    s_lshl_b32 s90, s90, 4
    s_add_u32 s90, s90, 9981952
    v_lshl_add_u32 v104, v104, 4, s90
    v_mul_u32_u24 v105, 10240, v106
    v_lshl_add_u32 v105, v107, 4, v105
    s_lshl_b32 s90, s93, 4
    s_add_u32 s90, s90, 7864320
    v_add_u32 v105, s90, v105
    s_waitcnt vmcnt(2)
    ds_read_b64_tr_b16 a[0:1], v100 offset:0
    ds_read_b64_tr_b16 a[2:3], v100 offset:512
    ds_read_b64_tr_b16 a[4:5], v101 offset:0
    ds_read_b64_tr_b16 a[6:7], v101 offset:512
    ds_read_b64_tr_b16 a[8:9], v102 offset:0
    ds_read_b64_tr_b16 a[10:11], v102 offset:512
    ds_read_b64_tr_b16 a[12:13], v103 offset:0
    ds_read_b64_tr_b16 a[14:15], v103 offset:512
    ds_read_b64_tr_b16 a[16:17], v100 offset:4096
    ds_read_b64_tr_b16 a[18:19], v100 offset:4608
    ds_read_b64_tr_b16 a[20:21], v101 offset:4096
    ds_read_b64_tr_b16 a[22:23], v101 offset:4608
    ds_read_b64_tr_b16 a[24:25], v102 offset:4096
    ds_read_b64_tr_b16 a[26:27], v102 offset:4608
    ds_read_b64_tr_b16 a[28:29], v103 offset:4096
    ds_read_b64_tr_b16 a[30:31], v103 offset:4608
    v_mov_b32 v2, 163732
    s_mov_b32 s99, 0
PK_XW2:
    ds_read_b32 v3, v2
    s_add_u32 s99, s99, 1
    s_cmp_gt_u32 s99, 2097152
    s_waitcnt lgkmcnt(0)
    v_cmp_gt_u32 vcc, 4, v3
    s_cbranch_scc1 PK_XW2_OK
    s_cbranch_vccnz PK_XW2
PK_XW2_OK:
    s_waitcnt vmcnt(0)
    v_mov_b32 v2, s80
    v_mov_b32 v3, s101
    s_mov_b64 exec, 1
    buffer_store_dword v2, v3, s[76:79], 0 offen sc1
    s_mov_b64 exec, -1
    s_add_u32 s90, s94, 2
    s_sub_u32 s91, s90, 12
    s_min_u32 s90, s90, s91
    s_add_u32 s90, s90, s95
    s_add_u32 m0, s85, 8192
    s_lshl_b32 s87, s90, 17
    buffer_load_dwordx4 v4, s[64:67], s87 offen offset:0 lds
    buffer_load_dwordx4 v5, s[64:67], s87 offen offset:1024 lds
    buffer_load_dwordx4 v6, s[64:67], s87 offen offset:2048 lds
    buffer_load_dwordx4 v7, s[64:67], s87 offen offset:3072 lds
    s_add_u32 s90, s94, 3
    s_sub_u32 s91, s90, 12
    s_min_u32 s90, s90, s91
    s_add_u32 s90, s90, s95
    s_add_u32 m0, s85, 12288
    s_lshl_b32 s87, s90, 17
    buffer_load_dwordx4 v4, s[64:67], s87 offen offset:0 lds
    buffer_load_dwordx4 v5, s[64:67], s87 offen offset:1024 lds
    buffer_load_dwordx4 v6, s[64:67], s87 offen offset:2048 lds
    buffer_load_dwordx4 v7, s[64:67], s87 offen offset:3072 lds
    s_add_u32 s90, s94, 4
    s_sub_u32 s91, s90, 12
    s_min_u32 s90, s90, s91
    s_add_u32 s90, s90, s95
    s_add_u32 m0, s85, 16384
    s_lshl_b32 s87, s90, 17
    buffer_load_dwordx4 v4, s[64:67], s87 offen offset:0 lds
    buffer_load_dwordx4 v5, s[64:67], s87 offen offset:1024 lds
    buffer_load_dwordx4 v6, s[64:67], s87 offen offset:2048 lds
    buffer_load_dwordx4 v7, s[64:67], s87 offen offset:3072 lds
    s_waitcnt vmcnt(8)
    ds_read_b64_tr_b16 a[32:33], v100 offset:8192
    ds_read_b64_tr_b16 a[34:35], v100 offset:8704
    ds_read_b64_tr_b16 a[36:37], v101 offset:8192
    ds_read_b64_tr_b16 a[38:39], v101 offset:8704
    ds_read_b64_tr_b16 a[40:41], v102 offset:8192
    ds_read_b64_tr_b16 a[42:43], v102 offset:8704
    ds_read_b64_tr_b16 a[44:45], v103 offset:8192
    ds_read_b64_tr_b16 a[46:47], v103 offset:8704
    s_waitcnt lgkmcnt(0)
    s_add_u32 s90, s94, 5
    s_sub_u32 s91, s90, 12
    s_min_u32 s90, s90, s91
    s_add_u32 s90, s90, s95
    s_add_u32 m0, s85, 20480
    s_lshl_b32 s87, s90, 17
    buffer_load_dwordx4 v4, s[64:67], s87 offen offset:0 lds
    buffer_load_dwordx4 v5, s[64:67], s87 offen offset:1024 lds
    buffer_load_dwordx4 v6, s[64:67], s87 offen offset:2048 lds
    buffer_load_dwordx4 v7, s[64:67], s87 offen offset:3072 lds
    s_add_u32 s90, s94, 6
    s_sub_u32 s91, s90, 12
    s_min_u32 s90, s90, s91
    s_add_u32 s90, s90, s95
    s_add_u32 m0, s85, 24576
    s_lshl_b32 s87, s90, 17
    buffer_load_dwordx4 v4, s[64:67], s87 offen offset:0 lds
    buffer_load_dwordx4 v5, s[64:67], s87 offen offset:1024 lds
    buffer_load_dwordx4 v6, s[64:67], s87 offen offset:2048 lds
    buffer_load_dwordx4 v7, s[64:67], s87 offen offset:3072 lds
    s_add_u32 s90, s94, 7
    s_sub_u32 s91, s90, 12
    s_min_u32 s90, s90, s91
    s_add_u32 s90, s90, s95
    s_add_u32 m0, s85, 0
    s_lshl_b32 s87, s90, 17
    buffer_load_dwordx4 v4, s[64:67], s87 offen offset:0 lds
    buffer_load_dwordx4 v5, s[64:67], s87 offen offset:1024 lds
    buffer_load_dwordx4 v6, s[64:67], s87 offen offset:2048 lds
    buffer_load_dwordx4 v7, s[64:67], s87 offen offset:3072 lds
    s_add_u32 s90, s94, 8
    s_sub_u32 s91, s90, 12
    s_min_u32 s90, s90, s91
    s_add_u32 s90, s90, s95
    s_add_u32 m0, s85, 4096
    s_lshl_b32 s87, s90, 17
    buffer_load_dwordx4 v4, s[64:67], s87 offen offset:0 lds
    buffer_load_dwordx4 v5, s[64:67], s87 offen offset:1024 lds
    buffer_load_dwordx4 v6, s[64:67], s87 offen offset:2048 lds
    buffer_load_dwordx4 v7, s[64:67], s87 offen offset:3072 lds
    s_add_u32 s90, s94, 9
    s_sub_u32 s91, s90, 12
    s_min_u32 s90, s90, s91
    s_add_u32 s90, s90, s95
    s_add_u32 m0, s85, 8192
    s_lshl_b32 s87, s90, 17
    buffer_load_dwordx4 v4, s[64:67], s87 offen offset:0 lds
    buffer_load_dwordx4 v5, s[64:67], s87 offen offset:1024 lds
    buffer_load_dwordx4 v6, s[64:67], s87 offen offset:2048 lds
    buffer_load_dwordx4 v7, s[64:67], s87 offen offset:3072 lds
    s_waitcnt vmcnt(24)
    ds_read_b64_tr_b16 a[48:49], v100 offset:12288
    ds_read_b64_tr_b16 a[50:51], v100 offset:12800
    ds_read_b64_tr_b16 a[52:53], v101 offset:12288
    ds_read_b64_tr_b16 a[54:55], v101 offset:12800
    ds_read_b64_tr_b16 a[56:57], v102 offset:12288
    ds_read_b64_tr_b16 a[58:59], v102 offset:12800
    ds_read_b64_tr_b16 a[60:61], v103 offset:12288
    ds_read_b64_tr_b16 a[62:63], v103 offset:12800
    s_waitcnt vmcnt(20)
    ds_read_b64_tr_b16 a[64:65], v100 offset:16384
    ds_read_b64_tr_b16 a[66:67], v100 offset:16896
    ds_read_b64_tr_b16 a[68:69], v101 offset:16384
    ds_read_b64_tr_b16 a[70:71], v101 offset:16896
    ds_read_b64_tr_b16 a[72:73], v102 offset:16384
    ds_read_b64_tr_b16 a[74:75], v102 offset:16896
    ds_read_b64_tr_b16 a[76:77], v103 offset:16384
    ds_read_b64_tr_b16 a[78:79], v103 offset:16896
    s_waitcnt lgkmcnt(0)
    s_add_u32 s90, s94, 10
    s_sub_u32 s91, s90, 12
    s_min_u32 s90, s90, s91
    s_add_u32 s90, s90, s95
    s_add_u32 m0, s85, 12288
    s_lshl_b32 s87, s90, 17
    buffer_load_dwordx4 v4, s[64:67], s87 offen offset:0 lds
    buffer_load_dwordx4 v5, s[64:67], s87 offen offset:1024 lds
    buffer_load_dwordx4 v6, s[64:67], s87 offen offset:2048 lds
    buffer_load_dwordx4 v7, s[64:67], s87 offen offset:3072 lds
    s_add_u32 s90, s94, 11
    s_sub_u32 s91, s90, 12
    s_min_u32 s90, s90, s91
    s_add_u32 s90, s90, s95
    s_add_u32 m0, s85, 16384
    s_lshl_b32 s87, s90, 17
    buffer_load_dwordx4 v4, s[64:67], s87 offen offset:0 lds
    buffer_load_dwordx4 v5, s[64:67], s87 offen offset:1024 lds
    buffer_load_dwordx4 v6, s[64:67], s87 offen offset:2048 lds
    buffer_load_dwordx4 v7, s[64:67], s87 offen offset:3072 lds
    buffer_load_dword v108, v104, s[76:79], 0 offen sc1
    v_mov_b32 v4, v100
    v_mov_b32 v5, v101
    v_mov_b32 v6, v102
    v_mov_b32 v7, v103
    v_mul_u32_u24 v109, 26, v1
    v_lshrrev_b32 v109, 8, v109
    v_mul_u32_u24 v110, 10, v109
    v_sub_u32 v110, v1, v110
    v_min_u32 v109, 5, v109
    v_mul_u32_u24 v109, 10240, v109
    v_lshl_add_u32 v109, v110, 7, v109
    s_and_b32 s90, s84, 7
    s_mul_i32 s90, s90, 6
    s_mul_i32 s91, s3, 48
    s_add_u32 s90, s90, s91
    s_mul_i32 s90, s90, 10240
    s_mul_i32 s91, s83, 1280
    s_add_u32 s90, s90, s91
    s_add_u32 s90, s90, 7864320
    v_add_u32 v109, s90, v109
    v_mov_b32 v3, v105
    s_waitcnt vmcnt(0)
    v_cmp_ne_u32 vcc, s80, v108
    s_cbranch_vccz PK_SPIN_U_OK
    s_mov_b32 s99, 0
PK_SPIN_U:
    s_sleep 4
    buffer_load_dword v108, v104, s[76:79], 0 offen sc1
    s_add_u32 s99, s99, 1
    s_waitcnt vmcnt(0)
    v_cmp_ne_u32 vcc, s80, v108
    s_cmp_gt_u32 s99, 20000
    s_cbranch_scc1 PK_SPIN_U_OK
    s_cbranch_vccnz PK_SPIN_U
PK_SPIN_U_OK:
    s_add_u32 s90, s94, 0
    s_sub_u32 s91, s90, 12
    s_min_u32 s90, s90, s91
    s_add_u32 s90, s90, s95
    s_mul_i32 s88, s90, 40960
    buffer_load_dwordx4 a[100:103], v3, s[76:79], s88 offen offset:0 sc1
    buffer_load_dwordx4 a[104:107], v3, s[76:79], s88 offen offset:256 sc1
    buffer_load_dwordx4 a[108:111], v3, s[76:79], s88 offen offset:512 sc1
    buffer_load_dwordx4 a[112:115], v3, s[76:79], s88 offen offset:768 sc1
    buffer_load_dwordx4 a[116:119], v3, s[76:79], s88 offen offset:1024 sc1
    s_add_u32 s90, s94, 1
    s_sub_u32 s91, s90, 12
    s_min_u32 s90, s90, s91
    s_add_u32 s90, s90, s95
    s_mul_i32 s88, s90, 40960
    buffer_load_dwordx4 v[8:11], v3, s[76:79], s88 offen offset:0 sc1
    buffer_load_dwordx4 v[12:15], v3, s[76:79], s88 offen offset:256 sc1
    buffer_load_dwordx4 v[16:19], v3, s[76:79], s88 offen offset:512 sc1
    buffer_load_dwordx4 v[20:23], v3, s[76:79], s88 offen offset:768 sc1
    buffer_load_dwordx4 v[24:27], v3, s[76:79], s88 offen offset:1024 sc1
    s_add_u32 s90, s94, 2
    s_sub_u32 s91, s90, 12
    s_min_u32 s90, s90, s91
    s_add_u32 s90, s90, s95
    s_mul_i32 s88, s90, 40960
    buffer_load_dwordx4 v[28:31], v3, s[76:79], s88 offen offset:0 sc1
    buffer_load_dwordx4 v[32:35], v3, s[76:79], s88 offen offset:256 sc1
    buffer_load_dwordx4 v[36:39], v3, s[76:79], s88 offen offset:512 sc1
    buffer_load_dwordx4 v[40:43], v3, s[76:79], s88 offen offset:768 sc1
    buffer_load_dwordx4 v[44:47], v3, s[76:79], s88 offen offset:1024 sc1
    s_add_u32 s90, s94, 3
    s_sub_u32 s91, s90, 12
    s_min_u32 s90, s90, s91
    s_add_u32 s90, s90, s95
    s_mul_i32 s88, s90, 40960
    buffer_load_dwordx4 a[80:83], v3, s[76:79], s88 offen offset:0 sc1
    buffer_load_dwordx4 a[84:87], v3, s[76:79], s88 offen offset:256 sc1
    buffer_load_dwordx4 a[88:91], v3, s[76:79], s88 offen offset:512 sc1
    buffer_load_dwordx4 a[92:95], v3, s[76:79], s88 offen offset:768 sc1
    buffer_load_dwordx4 a[96:99], v3, s[76:79], s88 offen offset:1024 sc1
    s_waitcnt lgkmcnt(0)
    s_add_u32 s90, s94, 4
    s_sub_u32 s91, s90, 12
    s_min_u32 s90, s90, s91
    s_add_u32 s90, s90, s95
    s_mul_i32 s88, s90, 40960
    s_waitcnt vmcnt(19)
    v_mfma_f32_16x16x32_bf16 v[48:51], a[100:103], a[0:3], 0
    v_mfma_f32_16x16x32_bf16 v[68:71], a[100:103], a[4:7], 0
    v_mfma_f32_16x16x32_bf16 v[88:91], a[100:103], a[8:11], 0
    v_mfma_f32_16x16x32_bf16 v[108:111], a[100:103], a[12:15], 0
    buffer_load_dwordx4 a[100:103], v3, s[76:79], s88 offen offset:0 sc1
    s_waitcnt vmcnt(19)
    v_mfma_f32_16x16x32_bf16 v[52:55], a[104:107], a[0:3], 0
    v_mfma_f32_16x16x32_bf16 v[72:75], a[104:107], a[4:7], 0
    v_mfma_f32_16x16x32_bf16 v[92:95], a[104:107], a[8:11], 0
    v_mfma_f32_16x16x32_bf16 v[112:115], a[104:107], a[12:15], 0
    buffer_load_dwordx4 a[104:107], v3, s[76:79], s88 offen offset:256 sc1
    s_waitcnt vmcnt(19)
    v_mfma_f32_16x16x32_bf16 v[56:59], a[108:111], a[0:3], 0
    v_mfma_f32_16x16x32_bf16 v[76:79], a[108:111], a[4:7], 0
    v_mfma_f32_16x16x32_bf16 v[96:99], a[108:111], a[8:11], 0
    v_mfma_f32_16x16x32_bf16 v[116:119], a[108:111], a[12:15], 0
    buffer_load_dwordx4 a[108:111], v3, s[76:79], s88 offen offset:512 sc1
    s_waitcnt vmcnt(19)
    v_mfma_f32_16x16x32_bf16 v[60:63], a[112:115], a[0:3], 0
    v_mfma_f32_16x16x32_bf16 v[80:83], a[112:115], a[4:7], 0
    v_mfma_f32_16x16x32_bf16 v[100:103], a[112:115], a[8:11], 0
    v_mfma_f32_16x16x32_bf16 v[120:123], a[112:115], a[12:15], 0
    buffer_load_dwordx4 a[112:115], v3, s[76:79], s88 offen offset:768 sc1
    s_waitcnt vmcnt(19)
    v_mfma_f32_16x16x32_bf16 v[64:67], a[116:119], a[0:3], 0
    v_mfma_f32_16x16x32_bf16 v[84:87], a[116:119], a[4:7], 0
    v_mfma_f32_16x16x32_bf16 v[104:107], a[116:119], a[8:11], 0
    v_mfma_f32_16x16x32_bf16 v[124:127], a[116:119], a[12:15], 0
    buffer_load_dwordx4 a[116:119], v3, s[76:79], s88 offen offset:1024 sc1
    s_add_u32 s90, s94, 5
    s_sub_u32 s91, s90, 12
    s_min_u32 s90, s90, s91
    s_add_u32 s90, s90, s95
    s_mul_i32 s88, s90, 40960
    s_waitcnt vmcnt(19)
    v_mfma_f32_16x16x32_bf16 v[48:51], v[8:11], a[16:19], v[48:51]
    ds_read_b64_tr_b16 a[0:1], v4 offset:20480
    v_mfma_f32_16x16x32_bf16 v[68:71], v[8:11], a[20:23], v[68:71]
    v_mfma_f32_16x16x32_bf16 v[88:91], v[8:11], a[24:27], v[88:91]
    ds_read_b64_tr_b16 a[2:3], v4 offset:20992
    v_mfma_f32_16x16x32_bf16 v[108:111], v[8:11], a[28:31], v[108:111]
    buffer_load_dwordx4 v[8:11], v3, s[76:79], s88 offen offset:0 sc1
    s_waitcnt vmcnt(19)
    v_mfma_f32_16x16x32_bf16 v[52:55], v[12:15], a[16:19], v[52:55]
    v_mfma_f32_16x16x32_bf16 v[72:75], v[12:15], a[20:23], v[72:75]
    ds_read_b64_tr_b16 a[4:5], v5 offset:20480
    v_mfma_f32_16x16x32_bf16 v[92:95], v[12:15], a[24:27], v[92:95]
    v_mfma_f32_16x16x32_bf16 v[112:115], v[12:15], a[28:31], v[112:115]
    ds_read_b64_tr_b16 a[6:7], v5 offset:20992
    buffer_load_dwordx4 v[12:15], v3, s[76:79], s88 offen offset:256 sc1
    s_waitcnt vmcnt(19)
    v_mfma_f32_16x16x32_bf16 v[56:59], v[16:19], a[16:19], v[56:59]
    v_mfma_f32_16x16x32_bf16 v[76:79], v[16:19], a[20:23], v[76:79]
    v_mfma_f32_16x16x32_bf16 v[96:99], v[16:19], a[24:27], v[96:99]
    ds_read_b64_tr_b16 a[8:9], v6 offset:20480
    v_mfma_f32_16x16x32_bf16 v[116:119], v[16:19], a[28:31], v[116:119]
    buffer_load_dwordx4 v[16:19], v3, s[76:79], s88 offen offset:512 sc1
    s_waitcnt vmcnt(19)
    v_mfma_f32_16x16x32_bf16 v[60:63], v[20:23], a[16:19], v[60:63]
    ds_read_b64_tr_b16 a[10:11], v6 offset:20992
    v_mfma_f32_16x16x32_bf16 v[80:83], v[20:23], a[20:23], v[80:83]
    v_mfma_f32_16x16x32_bf16 v[100:103], v[20:23], a[24:27], v[100:103]
    v_mfma_f32_16x16x32_bf16 v[120:123], v[20:23], a[28:31], v[120:123]
    ds_read_b64_tr_b16 a[12:13], v7 offset:20480
    buffer_load_dwordx4 v[20:23], v3, s[76:79], s88 offen offset:768 sc1
    s_waitcnt vmcnt(19)
    v_mfma_f32_16x16x32_bf16 v[64:67], v[24:27], a[16:19], v[64:67]
    v_mfma_f32_16x16x32_bf16 v[84:87], v[24:27], a[20:23], v[84:87]
    ds_read_b64_tr_b16 a[14:15], v7 offset:20992
    v_mfma_f32_16x16x32_bf16 v[104:107], v[24:27], a[24:27], v[104:107]
    v_mfma_f32_16x16x32_bf16 v[124:127], v[24:27], a[28:31], v[124:127]
    buffer_load_dwordx4 v[24:27], v3, s[76:79], s88 offen offset:1024 sc1
    s_add_u32 s90, s94, 6
    s_sub_u32 s91, s90, 12
    s_min_u32 s90, s90, s91
    s_add_u32 s90, s90, s95
    s_mul_i32 s88, s90, 40960
    s_waitcnt vmcnt(19)
    v_mfma_f32_16x16x32_bf16 v[48:51], v[28:31], a[32:35], v[48:51]
    ds_read_b64_tr_b16 a[16:17], v4 offset:24576
    v_mfma_f32_16x16x32_bf16 v[68:71], v[28:31], a[36:39], v[68:71]
    v_mfma_f32_16x16x32_bf16 v[88:91], v[28:31], a[40:43], v[88:91]
    ds_read_b64_tr_b16 a[18:19], v4 offset:25088
    v_mfma_f32_16x16x32_bf16 v[108:111], v[28:31], a[44:47], v[108:111]
    buffer_load_dwordx4 v[28:31], v3, s[76:79], s88 offen offset:0 sc1
    s_waitcnt vmcnt(19)
    v_mfma_f32_16x16x32_bf16 v[52:55], v[32:35], a[32:35], v[52:55]
    v_mfma_f32_16x16x32_bf16 v[72:75], v[32:35], a[36:39], v[72:75]
    ds_read_b64_tr_b16 a[20:21], v5 offset:24576
    v_mfma_f32_16x16x32_bf16 v[92:95], v[32:35], a[40:43], v[92:95]
    v_mfma_f32_16x16x32_bf16 v[112:115], v[32:35], a[44:47], v[112:115]
    ds_read_b64_tr_b16 a[22:23], v5 offset:25088
    buffer_load_dwordx4 v[32:35], v3, s[76:79], s88 offen offset:256 sc1
    s_waitcnt vmcnt(19)
    v_mfma_f32_16x16x32_bf16 v[56:59], v[36:39], a[32:35], v[56:59]
    v_mfma_f32_16x16x32_bf16 v[76:79], v[36:39], a[36:39], v[76:79]
    v_mfma_f32_16x16x32_bf16 v[96:99], v[36:39], a[40:43], v[96:99]
    ds_read_b64_tr_b16 a[24:25], v6 offset:24576
    v_mfma_f32_16x16x32_bf16 v[116:119], v[36:39], a[44:47], v[116:119]
    buffer_load_dwordx4 v[36:39], v3, s[76:79], s88 offen offset:512 sc1
    s_waitcnt vmcnt(19)
    v_mfma_f32_16x16x32_bf16 v[60:63], v[40:43], a[32:35], v[60:63]
    ds_read_b64_tr_b16 a[26:27], v6 offset:25088
    v_mfma_f32_16x16x32_bf16 v[80:83], v[40:43], a[36:39], v[80:83]
    v_mfma_f32_16x16x32_bf16 v[100:103], v[40:43], a[40:43], v[100:103]
    v_mfma_f32_16x16x32_bf16 v[120:123], v[40:43], a[44:47], v[120:123]
    ds_read_b64_tr_b16 a[28:29], v7 offset:24576
    buffer_load_dwordx4 v[40:43], v3, s[76:79], s88 offen offset:768 sc1
    s_waitcnt vmcnt(19)
    v_mfma_f32_16x16x32_bf16 v[64:67], v[44:47], a[32:35], v[64:67]
    v_mfma_f32_16x16x32_bf16 v[84:87], v[44:47], a[36:39], v[84:87]
    ds_read_b64_tr_b16 a[30:31], v7 offset:25088
    v_mfma_f32_16x16x32_bf16 v[104:107], v[44:47], a[40:43], v[104:107]
    v_mfma_f32_16x16x32_bf16 v[124:127], v[44:47], a[44:47], v[124:127]
    buffer_load_dwordx4 v[44:47], v3, s[76:79], s88 offen offset:1024 sc1
    s_add_u32 s90, s94, 7
    s_sub_u32 s91, s90, 12
    s_min_u32 s90, s90, s91
    s_add_u32 s90, s90, s95
    s_mul_i32 s88, s90, 40960
    s_waitcnt vmcnt(19)
    v_mfma_f32_16x16x32_bf16 v[48:51], a[80:83], a[48:51], v[48:51]
    ds_read_b64_tr_b16 a[32:33], v4 offset:0
    v_mfma_f32_16x16x32_bf16 v[68:71], a[80:83], a[52:55], v[68:71]
    v_mfma_f32_16x16x32_bf16 v[88:91], a[80:83], a[56:59], v[88:91]
    ds_read_b64_tr_b16 a[34:35], v4 offset:512
    v_mfma_f32_16x16x32_bf16 v[108:111], a[80:83], a[60:63], v[108:111]
    buffer_load_dwordx4 a[80:83], v3, s[76:79], s88 offen offset:0 sc1
    s_waitcnt vmcnt(19)
    v_mfma_f32_16x16x32_bf16 v[52:55], a[84:87], a[48:51], v[52:55]
    v_mfma_f32_16x16x32_bf16 v[72:75], a[84:87], a[52:55], v[72:75]
    ds_read_b64_tr_b16 a[36:37], v5 offset:0
    v_mfma_f32_16x16x32_bf16 v[92:95], a[84:87], a[56:59], v[92:95]
    v_mfma_f32_16x16x32_bf16 v[112:115], a[84:87], a[60:63], v[112:115]
    ds_read_b64_tr_b16 a[38:39], v5 offset:512
    buffer_load_dwordx4 a[84:87], v3, s[76:79], s88 offen offset:256 sc1
    s_waitcnt vmcnt(19)
    v_mfma_f32_16x16x32_bf16 v[56:59], a[88:91], a[48:51], v[56:59]
    v_mfma_f32_16x16x32_bf16 v[76:79], a[88:91], a[52:55], v[76:79]
    v_mfma_f32_16x16x32_bf16 v[96:99], a[88:91], a[56:59], v[96:99]
    ds_read_b64_tr_b16 a[40:41], v6 offset:0
    v_mfma_f32_16x16x32_bf16 v[116:119], a[88:91], a[60:63], v[116:119]
    buffer_load_dwordx4 a[88:91], v3, s[76:79], s88 offen offset:512 sc1
    s_waitcnt vmcnt(19)
    v_mfma_f32_16x16x32_bf16 v[60:63], a[92:95], a[48:51], v[60:63]
    ds_read_b64_tr_b16 a[42:43], v6 offset:512
    v_mfma_f32_16x16x32_bf16 v[80:83], a[92:95], a[52:55], v[80:83]
    v_mfma_f32_16x16x32_bf16 v[100:103], a[92:95], a[56:59], v[100:103]
    v_mfma_f32_16x16x32_bf16 v[120:123], a[92:95], a[60:63], v[120:123]
    ds_read_b64_tr_b16 a[44:45], v7 offset:0
    buffer_load_dwordx4 a[92:95], v3, s[76:79], s88 offen offset:768 sc1
    s_waitcnt vmcnt(19)
    v_mfma_f32_16x16x32_bf16 v[64:67], a[96:99], a[48:51], v[64:67]
    v_mfma_f32_16x16x32_bf16 v[84:87], a[96:99], a[52:55], v[84:87]
    ds_read_b64_tr_b16 a[46:47], v7 offset:512
    v_mfma_f32_16x16x32_bf16 v[104:107], a[96:99], a[56:59], v[104:107]
    v_mfma_f32_16x16x32_bf16 v[124:127], a[96:99], a[60:63], v[124:127]
    buffer_load_dwordx4 a[96:99], v3, s[76:79], s88 offen offset:1024 sc1
    s_add_u32 s90, s94, 8
    s_sub_u32 s91, s90, 12
    s_min_u32 s90, s90, s91
    s_add_u32 s90, s90, s95
    s_mul_i32 s88, s90, 40960
    s_waitcnt vmcnt(19)
    v_mfma_f32_16x16x32_bf16 v[48:51], a[100:103], a[64:67], v[48:51]
    ds_read_b64_tr_b16 a[48:49], v4 offset:4096
    v_mfma_f32_16x16x32_bf16 v[68:71], a[100:103], a[68:71], v[68:71]
    v_mfma_f32_16x16x32_bf16 v[88:91], a[100:103], a[72:75], v[88:91]
    ds_read_b64_tr_b16 a[50:51], v4 offset:4608
    v_mfma_f32_16x16x32_bf16 v[108:111], a[100:103], a[76:79], v[108:111]
    buffer_load_dwordx4 a[100:103], v3, s[76:79], s88 offen offset:0 sc1
    s_waitcnt vmcnt(19)
    v_mfma_f32_16x16x32_bf16 v[52:55], a[104:107], a[64:67], v[52:55]
    v_mfma_f32_16x16x32_bf16 v[72:75], a[104:107], a[68:71], v[72:75]
    ds_read_b64_tr_b16 a[52:53], v5 offset:4096
    v_mfma_f32_16x16x32_bf16 v[92:95], a[104:107], a[72:75], v[92:95]
    v_mfma_f32_16x16x32_bf16 v[112:115], a[104:107], a[76:79], v[112:115]
    ds_read_b64_tr_b16 a[54:55], v5 offset:4608
    buffer_load_dwordx4 a[104:107], v3, s[76:79], s88 offen offset:256 sc1
    s_waitcnt vmcnt(19)
    v_mfma_f32_16x16x32_bf16 v[56:59], a[108:111], a[64:67], v[56:59]
    v_mfma_f32_16x16x32_bf16 v[76:79], a[108:111], a[68:71], v[76:79]
    v_mfma_f32_16x16x32_bf16 v[96:99], a[108:111], a[72:75], v[96:99]
    ds_read_b64_tr_b16 a[56:57], v6 offset:4096
    v_mfma_f32_16x16x32_bf16 v[116:119], a[108:111], a[76:79], v[116:119]
    buffer_load_dwordx4 a[108:111], v3, s[76:79], s88 offen offset:512 sc1
    s_waitcnt vmcnt(19)
    v_mfma_f32_16x16x32_bf16 v[60:63], a[112:115], a[64:67], v[60:63]
    ds_read_b64_tr_b16 a[58:59], v6 offset:4608
    v_mfma_f32_16x16x32_bf16 v[80:83], a[112:115], a[68:71], v[80:83]
    v_mfma_f32_16x16x32_bf16 v[100:103], a[112:115], a[72:75], v[100:103]
    v_mfma_f32_16x16x32_bf16 v[120:123], a[112:115], a[76:79], v[120:123]
    ds_read_b64_tr_b16 a[60:61], v7 offset:4096
    buffer_load_dwordx4 a[112:115], v3, s[76:79], s88 offen offset:768 sc1
    s_waitcnt vmcnt(19)
    v_mfma_f32_16x16x32_bf16 v[64:67], a[116:119], a[64:67], v[64:67]
    v_mfma_f32_16x16x32_bf16 v[84:87], a[116:119], a[68:71], v[84:87]
    ds_read_b64_tr_b16 a[62:63], v7 offset:4608
    v_mfma_f32_16x16x32_bf16 v[104:107], a[116:119], a[72:75], v[104:107]
    v_mfma_f32_16x16x32_bf16 v[124:127], a[116:119], a[76:79], v[124:127]
    buffer_load_dwordx4 a[116:119], v3, s[76:79], s88 offen offset:1024 sc1
    s_add_u32 s90, s94, 9
    s_sub_u32 s91, s90, 12
    s_min_u32 s90, s90, s91
    s_add_u32 s90, s90, s95
    s_mul_i32 s88, s90, 40960
    s_waitcnt lgkmcnt(8)
    s_waitcnt vmcnt(19)
    v_mfma_f32_16x16x32_bf16 v[48:51], v[8:11], a[0:3], v[48:51]
    ds_read_b64_tr_b16 a[64:65], v4 offset:8192
    v_mfma_f32_16x16x32_bf16 v[68:71], v[8:11], a[4:7], v[68:71]
    v_mfma_f32_16x16x32_bf16 v[88:91], v[8:11], a[8:11], v[88:91]
    ds_read_b64_tr_b16 a[66:67], v4 offset:8704
    v_mfma_f32_16x16x32_bf16 v[108:111], v[8:11], a[12:15], v[108:111]
    buffer_load_dwordx4 v[8:11], v3, s[76:79], s88 offen offset:0 sc1
    s_waitcnt vmcnt(19)
    v_mfma_f32_16x16x32_bf16 v[52:55], v[12:15], a[0:3], v[52:55]
    v_mfma_f32_16x16x32_bf16 v[72:75], v[12:15], a[4:7], v[72:75]
    ds_read_b64_tr_b16 a[68:69], v5 offset:8192
    v_mfma_f32_16x16x32_bf16 v[92:95], v[12:15], a[8:11], v[92:95]
    v_mfma_f32_16x16x32_bf16 v[112:115], v[12:15], a[12:15], v[112:115]
    ds_read_b64_tr_b16 a[70:71], v5 offset:8704
    buffer_load_dwordx4 v[12:15], v3, s[76:79], s88 offen offset:256 sc1
    s_waitcnt vmcnt(19)
    v_mfma_f32_16x16x32_bf16 v[56:59], v[16:19], a[0:3], v[56:59]
    v_mfma_f32_16x16x32_bf16 v[76:79], v[16:19], a[4:7], v[76:79]
    v_mfma_f32_16x16x32_bf16 v[96:99], v[16:19], a[8:11], v[96:99]
    ds_read_b64_tr_b16 a[72:73], v6 offset:8192
    v_mfma_f32_16x16x32_bf16 v[116:119], v[16:19], a[12:15], v[116:119]
    buffer_load_dwordx4 v[16:19], v3, s[76:79], s88 offen offset:512 sc1
    s_waitcnt vmcnt(19)
    v_mfma_f32_16x16x32_bf16 v[60:63], v[20:23], a[0:3], v[60:63]
    ds_read_b64_tr_b16 a[74:75], v6 offset:8704
    v_mfma_f32_16x16x32_bf16 v[80:83], v[20:23], a[4:7], v[80:83]
    v_mfma_f32_16x16x32_bf16 v[100:103], v[20:23], a[8:11], v[100:103]
    v_mfma_f32_16x16x32_bf16 v[120:123], v[20:23], a[12:15], v[120:123]
    ds_read_b64_tr_b16 a[76:77], v7 offset:8192
    buffer_load_dwordx4 v[20:23], v3, s[76:79], s88 offen offset:768 sc1
    s_waitcnt vmcnt(19)
    v_mfma_f32_16x16x32_bf16 v[64:67], v[24:27], a[0:3], v[64:67]
    v_mfma_f32_16x16x32_bf16 v[84:87], v[24:27], a[4:7], v[84:87]
    ds_read_b64_tr_b16 a[78:79], v7 offset:8704
    v_mfma_f32_16x16x32_bf16 v[104:107], v[24:27], a[8:11], v[104:107]
    v_mfma_f32_16x16x32_bf16 v[124:127], v[24:27], a[12:15], v[124:127]
    buffer_load_dwordx4 v[24:27], v3, s[76:79], s88 offen offset:1024 sc1
    s_add_u32 s90, s94, 10
    s_sub_u32 s91, s90, 12
    s_min_u32 s90, s90, s91
    s_add_u32 s90, s90, s95
    s_mul_i32 s88, s90, 40960
    s_waitcnt lgkmcnt(8)
    s_waitcnt vmcnt(19)
    v_mfma_f32_16x16x32_bf16 v[48:51], v[28:31], a[16:19], v[48:51]
    ds_read_b64_tr_b16 a[0:1], v4 offset:12288
    v_mfma_f32_16x16x32_bf16 v[68:71], v[28:31], a[20:23], v[68:71]
    v_mfma_f32_16x16x32_bf16 v[88:91], v[28:31], a[24:27], v[88:91]
    ds_read_b64_tr_b16 a[2:3], v4 offset:12800
    v_mfma_f32_16x16x32_bf16 v[108:111], v[28:31], a[28:31], v[108:111]
    buffer_load_dwordx4 v[28:31], v3, s[76:79], s88 offen offset:0 sc1
    s_waitcnt vmcnt(19)
    v_mfma_f32_16x16x32_bf16 v[52:55], v[32:35], a[16:19], v[52:55]
    v_mfma_f32_16x16x32_bf16 v[72:75], v[32:35], a[20:23], v[72:75]
    ds_read_b64_tr_b16 a[4:5], v5 offset:12288
    v_mfma_f32_16x16x32_bf16 v[92:95], v[32:35], a[24:27], v[92:95]
    v_mfma_f32_16x16x32_bf16 v[112:115], v[32:35], a[28:31], v[112:115]
    ds_read_b64_tr_b16 a[6:7], v5 offset:12800
    buffer_load_dwordx4 v[32:35], v3, s[76:79], s88 offen offset:256 sc1
    s_waitcnt vmcnt(19)
    v_mfma_f32_16x16x32_bf16 v[56:59], v[36:39], a[16:19], v[56:59]
    v_mfma_f32_16x16x32_bf16 v[76:79], v[36:39], a[20:23], v[76:79]
    v_mfma_f32_16x16x32_bf16 v[96:99], v[36:39], a[24:27], v[96:99]
    ds_read_b64_tr_b16 a[8:9], v6 offset:12288
    v_mfma_f32_16x16x32_bf16 v[116:119], v[36:39], a[28:31], v[116:119]
    buffer_load_dwordx4 v[36:39], v3, s[76:79], s88 offen offset:512 sc1
    s_waitcnt vmcnt(19)
    v_mfma_f32_16x16x32_bf16 v[60:63], v[40:43], a[16:19], v[60:63]
    ds_read_b64_tr_b16 a[10:11], v6 offset:12800
    v_mfma_f32_16x16x32_bf16 v[80:83], v[40:43], a[20:23], v[80:83]
    v_mfma_f32_16x16x32_bf16 v[100:103], v[40:43], a[24:27], v[100:103]
    v_mfma_f32_16x16x32_bf16 v[120:123], v[40:43], a[28:31], v[120:123]
    ds_read_b64_tr_b16 a[12:13], v7 offset:12288
    buffer_load_dwordx4 v[40:43], v3, s[76:79], s88 offen offset:768 sc1
    s_waitcnt vmcnt(19)
    v_mfma_f32_16x16x32_bf16 v[64:67], v[44:47], a[16:19], v[64:67]
    v_mfma_f32_16x16x32_bf16 v[84:87], v[44:47], a[20:23], v[84:87]
    ds_read_b64_tr_b16 a[14:15], v7 offset:12800
    v_mfma_f32_16x16x32_bf16 v[104:107], v[44:47], a[24:27], v[104:107]
    v_mfma_f32_16x16x32_bf16 v[124:127], v[44:47], a[28:31], v[124:127]
    buffer_load_dwordx4 v[44:47], v3, s[76:79], s88 offen offset:1024 sc1
    s_add_u32 s90, s94, 11
    s_sub_u32 s91, s90, 12
    s_min_u32 s90, s90, s91
    s_add_u32 s90, s90, s95
    s_mul_i32 s88, s90, 40960
    s_waitcnt lgkmcnt(8)
    v_mov_b32 v2, 163748
    s_mov_b64 exec, 1
    ds_add_u32 v2, v2
    s_mov_b64 exec, -1
    s_waitcnt vmcnt(19)
    v_mfma_f32_16x16x32_bf16 v[48:51], a[80:83], a[32:35], v[48:51]
    ds_read_b64_tr_b16 a[16:17], v4 offset:16384
    v_mfma_f32_16x16x32_bf16 v[68:71], a[80:83], a[36:39], v[68:71]
    v_mfma_f32_16x16x32_bf16 v[88:91], a[80:83], a[40:43], v[88:91]
    ds_read_b64_tr_b16 a[18:19], v4 offset:16896
    v_mfma_f32_16x16x32_bf16 v[108:111], a[80:83], a[44:47], v[108:111]
    buffer_load_dwordx4 a[80:83], v3, s[76:79], s88 offen offset:0 sc1
    s_waitcnt vmcnt(19)
    v_mfma_f32_16x16x32_bf16 v[52:55], a[84:87], a[32:35], v[52:55]
    v_mfma_f32_16x16x32_bf16 v[72:75], a[84:87], a[36:39], v[72:75]
    ds_read_b64_tr_b16 a[20:21], v5 offset:16384
    v_mfma_f32_16x16x32_bf16 v[92:95], a[84:87], a[40:43], v[92:95]
    v_mfma_f32_16x16x32_bf16 v[112:115], a[84:87], a[44:47], v[112:115]
    ds_read_b64_tr_b16 a[22:23], v5 offset:16896
    buffer_load_dwordx4 a[84:87], v3, s[76:79], s88 offen offset:256 sc1
    s_waitcnt vmcnt(19)
    v_mfma_f32_16x16x32_bf16 v[56:59], a[88:91], a[32:35], v[56:59]
    v_mfma_f32_16x16x32_bf16 v[76:79], a[88:91], a[36:39], v[76:79]
    v_mfma_f32_16x16x32_bf16 v[96:99], a[88:91], a[40:43], v[96:99]
    ds_read_b64_tr_b16 a[24:25], v6 offset:16384
    v_mfma_f32_16x16x32_bf16 v[116:119], a[88:91], a[44:47], v[116:119]
    buffer_load_dwordx4 a[88:91], v3, s[76:79], s88 offen offset:512 sc1
    s_waitcnt vmcnt(19)
    v_mfma_f32_16x16x32_bf16 v[60:63], a[92:95], a[32:35], v[60:63]
    ds_read_b64_tr_b16 a[26:27], v6 offset:16896
    v_mfma_f32_16x16x32_bf16 v[80:83], a[92:95], a[36:39], v[80:83]
    v_mfma_f32_16x16x32_bf16 v[100:103], a[92:95], a[40:43], v[100:103]
    v_mfma_f32_16x16x32_bf16 v[120:123], a[92:95], a[44:47], v[120:123]
    ds_read_b64_tr_b16 a[28:29], v7 offset:16384
    buffer_load_dwordx4 a[92:95], v3, s[76:79], s88 offen offset:768 sc1
    s_waitcnt vmcnt(19)
    v_mfma_f32_16x16x32_bf16 v[64:67], a[96:99], a[32:35], v[64:67]
    v_mfma_f32_16x16x32_bf16 v[84:87], a[96:99], a[36:39], v[84:87]
    ds_read_b64_tr_b16 a[30:31], v7 offset:16896
    v_mfma_f32_16x16x32_bf16 v[104:107], a[96:99], a[40:43], v[104:107]
    v_mfma_f32_16x16x32_bf16 v[124:127], a[96:99], a[44:47], v[124:127]
    buffer_load_dwordx4 a[96:99], v3, s[76:79], s88 offen offset:1024 sc1
    s_waitcnt lgkmcnt(8)
    s_waitcnt vmcnt(19)
    v_mfma_f32_16x16x32_bf16 v[48:51], a[100:103], a[48:51], v[48:51]
    v_mfma_f32_16x16x32_bf16 v[68:71], a[100:103], a[52:55], v[68:71]
    v_mfma_f32_16x16x32_bf16 v[88:91], a[100:103], a[56:59], v[88:91]
    v_mfma_f32_16x16x32_bf16 v[108:111], a[100:103], a[60:63], v[108:111]
    s_waitcnt vmcnt(18)
    v_mfma_f32_16x16x32_bf16 v[52:55], a[104:107], a[48:51], v[52:55]
    v_mfma_f32_16x16x32_bf16 v[72:75], a[104:107], a[52:55], v[72:75]
    v_mfma_f32_16x16x32_bf16 v[92:95], a[104:107], a[56:59], v[92:95]
    v_mfma_f32_16x16x32_bf16 v[112:115], a[104:107], a[60:63], v[112:115]
    s_waitcnt vmcnt(17)
    v_mfma_f32_16x16x32_bf16 v[56:59], a[108:111], a[48:51], v[56:59]
    v_mfma_f32_16x16x32_bf16 v[76:79], a[108:111], a[52:55], v[76:79]
    v_mfma_f32_16x16x32_bf16 v[96:99], a[108:111], a[56:59], v[96:99]
    v_mfma_f32_16x16x32_bf16 v[116:119], a[108:111], a[60:63], v[116:119]
    s_waitcnt vmcnt(16)
    v_mfma_f32_16x16x32_bf16 v[60:63], a[112:115], a[48:51], v[60:63]
    v_mfma_f32_16x16x32_bf16 v[80:83], a[112:115], a[52:55], v[80:83]
    v_mfma_f32_16x16x32_bf16 v[100:103], a[112:115], a[56:59], v[100:103]
    v_mfma_f32_16x16x32_bf16 v[120:123], a[112:115], a[60:63], v[120:123]
    s_waitcnt vmcnt(15)
    v_mfma_f32_16x16x32_bf16 v[64:67], a[116:119], a[48:51], v[64:67]
    v_mfma_f32_16x16x32_bf16 v[84:87], a[116:119], a[52:55], v[84:87]
    v_mfma_f32_16x16x32_bf16 v[104:107], a[116:119], a[56:59], v[104:107]
    v_mfma_f32_16x16x32_bf16 v[124:127], a[116:119], a[60:63], v[124:127]
    s_waitcnt lgkmcnt(0)
    s_waitcnt vmcnt(14)
    v_mfma_f32_16x16x32_bf16 v[48:51], v[8:11], a[64:67], v[48:51]
    v_mfma_f32_16x16x32_bf16 v[68:71], v[8:11], a[68:71], v[68:71]
    v_mfma_f32_16x16x32_bf16 v[88:91], v[8:11], a[72:75], v[88:91]
    v_mfma_f32_16x16x32_bf16 v[108:111], v[8:11], a[76:79], v[108:111]
    s_waitcnt vmcnt(13)
    v_mfma_f32_16x16x32_bf16 v[52:55], v[12:15], a[64:67], v[52:55]
    v_mfma_f32_16x16x32_bf16 v[72:75], v[12:15], a[68:71], v[72:75]
    v_mfma_f32_16x16x32_bf16 v[92:95], v[12:15], a[72:75], v[92:95]
    v_mfma_f32_16x16x32_bf16 v[112:115], v[12:15], a[76:79], v[112:115]
    s_waitcnt vmcnt(12)
    v_mfma_f32_16x16x32_bf16 v[56:59], v[16:19], a[64:67], v[56:59]
    v_mfma_f32_16x16x32_bf16 v[76:79], v[16:19], a[68:71], v[76:79]
    v_mfma_f32_16x16x32_bf16 v[96:99], v[16:19], a[72:75], v[96:99]
    v_mfma_f32_16x16x32_bf16 v[116:119], v[16:19], a[76:79], v[116:119]
    s_waitcnt vmcnt(11)
    v_mfma_f32_16x16x32_bf16 v[60:63], v[20:23], a[64:67], v[60:63]
    v_mfma_f32_16x16x32_bf16 v[80:83], v[20:23], a[68:71], v[80:83]
    v_mfma_f32_16x16x32_bf16 v[100:103], v[20:23], a[72:75], v[100:103]
    v_mfma_f32_16x16x32_bf16 v[120:123], v[20:23], a[76:79], v[120:123]
    s_waitcnt vmcnt(10)
    v_mfma_f32_16x16x32_bf16 v[64:67], v[24:27], a[64:67], v[64:67]
    v_mfma_f32_16x16x32_bf16 v[84:87], v[24:27], a[68:71], v[84:87]
    v_mfma_f32_16x16x32_bf16 v[104:107], v[24:27], a[72:75], v[104:107]
    v_mfma_f32_16x16x32_bf16 v[124:127], v[24:27], a[76:79], v[124:127]
    v_lshrrev_b32 v8, 4, v1
    v_and_b32 v9, 15, v1
    s_lshl_b32 s90, s84, 6
    s_lshl_b32 s91, s3, 4
    s_add_u32 s90, s90, s91
    v_add_u32 v9, s90, v9
    v_mul_u32_u24 v10, 1280, v9
    v_lshl_add_u32 v10, v8, 3, v10
    s_mul_i32 s90, s83, 160
    v_add_u32 v10, s90, v10
    v_lshlrev_b32 v9, 1, v9
    buffer_load_ushort v16, v9, s[68:71], 0 offen
    v_lshl_add_u32 v11, v1, 4, s85
    s_mul_i32 s90, s3, 2560
    s_add_u32 s90, s90, 153472
    v_lshl_add_u32 v15, v1, 3, s90
    s_mul_i32 s90, s3, 5120
    v_lshl_add_u32 v12, v1, 4, s90
    v_add_u32 v13, 57344, v12
    s_waitcnt vmcnt(1)
    v_mfma_f32_16x16x32_bf16 v[48:51], v[28:31], a[0:3], v[48:51]
    v_mfma_f32_16x16x32_bf16 v[52:55], v[32:35], a[0:3], v[52:55]
    v_mfma_f32_16x16x32_bf16 v[56:59], v[36:39], a[0:3], v[56:59]
    v_mfma_f32_16x16x32_bf16 v[60:63], v[40:43], a[0:3], v[60:63]
    v_mfma_f32_16x16x32_bf16 v[64:67], v[44:47], a[0:3], v[64:67]
    v_mfma_f32_16x16x32_bf16 v[48:51], a[80:83], a[16:19], v[48:51]
    v_mfma_f32_16x16x32_bf16 v[52:55], a[84:87], a[16:19], v[52:55]
    v_mfma_f32_16x16x32_bf16 v[56:59], a[88:91], a[16:19], v[56:59]
    v_mfma_f32_16x16x32_bf16 v[60:63], a[92:95], a[16:19], v[60:63]
    v_mfma_f32_16x16x32_bf16 v[64:67], a[96:99], a[16:19], v[64:67]
    v_mfma_f32_16x16x32_bf16 v[68:71], v[28:31], a[4:7], v[68:71]
    v_mfma_f32_16x16x32_bf16 v[72:75], v[32:35], a[4:7], v[72:75]
    v_mfma_f32_16x16x32_bf16 v[76:79], v[36:39], a[4:7], v[76:79]
    v_mfma_f32_16x16x32_bf16 v[80:83], v[40:43], a[4:7], v[80:83]
    v_mfma_f32_16x16x32_bf16 v[84:87], v[44:47], a[4:7], v[84:87]
    ds_write_b128 v11, v[48:51] offset:0
    v_mfma_f32_16x16x32_bf16 v[68:71], a[80:83], a[20:23], v[68:71]
    ds_write_b128 v11, v[52:55] offset:1024
    v_mfma_f32_16x16x32_bf16 v[72:75], a[84:87], a[20:23], v[72:75]
    ds_write_b128 v11, v[56:59] offset:2048
    v_mfma_f32_16x16x32_bf16 v[76:79], a[88:91], a[20:23], v[76:79]
    ds_write_b128 v11, v[60:63] offset:3072
    v_mfma_f32_16x16x32_bf16 v[80:83], a[92:95], a[20:23], v[80:83]
    ds_write_b128 v11, v[64:67] offset:4096
    v_mfma_f32_16x16x32_bf16 v[84:87], a[96:99], a[20:23], v[84:87]
    v_mfma_f32_16x16x32_bf16 v[88:91], v[28:31], a[8:11], v[88:91]
    v_mfma_f32_16x16x32_bf16 v[92:95], v[32:35], a[8:11], v[92:95]
    ds_write_b128 v11, v[68:71] offset:5120
    v_mfma_f32_16x16x32_bf16 v[96:99], v[36:39], a[8:11], v[96:99]
    ds_write_b128 v11, v[72:75] offset:6144
    v_mfma_f32_16x16x32_bf16 v[100:103], v[40:43], a[8:11], v[100:103]
    ds_write_b128 v11, v[76:79] offset:7168
    v_mfma_f32_16x16x32_bf16 v[104:107], v[44:47], a[8:11], v[104:107]
    ds_write_b128 v11, v[80:83] offset:8192
    v_mfma_f32_16x16x32_bf16 v[88:91], a[80:83], a[24:27], v[88:91]
    ds_write_b128 v11, v[84:87] offset:9216
    v_mfma_f32_16x16x32_bf16 v[92:95], a[84:87], a[24:27], v[92:95]
    v_mfma_f32_16x16x32_bf16 v[96:99], a[88:91], a[24:27], v[96:99]
    v_mfma_f32_16x16x32_bf16 v[100:103], a[92:95], a[24:27], v[100:103]
    v_mfma_f32_16x16x32_bf16 v[104:107], a[96:99], a[24:27], v[104:107]
    v_mfma_f32_16x16x32_bf16 v[108:111], v[28:31], a[12:15], v[108:111]
    v_mfma_f32_16x16x32_bf16 v[112:115], v[32:35], a[12:15], v[112:115]
    v_mfma_f32_16x16x32_bf16 v[116:119], v[36:39], a[12:15], v[116:119]
    v_mfma_f32_16x16x32_bf16 v[120:123], v[40:43], a[12:15], v[120:123]
    v_mfma_f32_16x16x32_bf16 v[124:127], v[44:47], a[12:15], v[124:127]
    ds_write_b128 v11, v[88:91] offset:10240
    v_mfma_f32_16x16x32_bf16 v[108:111], a[80:83], a[28:31], v[108:111]
    ds_write_b128 v11, v[92:95] offset:11264
    v_mfma_f32_16x16x32_bf16 v[112:115], a[84:87], a[28:31], v[112:115]
    ds_write_b128 v11, v[96:99] offset:12288
    v_mfma_f32_16x16x32_bf16 v[116:119], a[88:91], a[28:31], v[116:119]
    ds_write_b128 v11, v[100:103] offset:13312
    v_mfma_f32_16x16x32_bf16 v[120:123], a[92:95], a[28:31], v[120:123]
    ds_write_b128 v11, v[104:107] offset:14336
    v_mfma_f32_16x16x32_bf16 v[124:127], a[96:99], a[28:31], v[124:127]
    s_nop 1
    ds_write_b128 v11, v[108:111] offset:15360
    s_nop 0
    ds_write_b128 v11, v[112:115] offset:16384
    s_nop 0
    ds_write_b128 v11, v[116:119] offset:17408
    s_nop 0
    ds_write_b128 v11, v[120:123] offset:18432
    ds_write_b128 v11, v[124:127] offset:19456
    v_mov_b32 v2, 163756
    v_mov_b32 v3, 1
    s_waitcnt lgkmcnt(0)
    s_mov_b64 exec, 1
    ds_add_u32 v2, v3
    s_mov_b64 exec, -1
    s_waitcnt vmcnt(0)
    v_lshlrev_b32 v17, 16, v16
    v_lshlrev_b32 v16, 16, v16
    v_mov_b32 v2, 163756
    s_mov_b32 s99, 0
PK_GB3:
    ds_read_b32 v3, v2
    s_add_u32 s99, s99, 1
    s_cmp_gt_u32 s99, 2097152
    s_waitcnt lgkmcnt(0)
    v_cmp_gt_u32 vcc, 4, v3
    s_cbranch_scc1 PK_GB3_OK
    s_cbranch_vccnz PK_GB3
PK_GB3_OK:
    ds_read_b128 v[48:51], v12 offset:0
    ds_read_b128 v[52:55], v12 offset:1024
    ds_read_b128 v[56:59], v12 offset:2048
    ds_read_b128 v[68:71], v12 offset:28672
    ds_read_b128 v[72:75], v12 offset:29696
    ds_read_b128 v[76:79], v12 offset:30720
    ds_read_b128 v[88:91], v13 offset:0
    ds_read_b128 v[92:95], v13 offset:1024
    ds_read_b128 v[96:99], v13 offset:2048
    ds_read_b128 v[108:111], v13 offset:28672
    ds_read_b128 v[112:115], v13 offset:29696
    ds_read_b128 v[116:119], v13 offset:30720
    s_waitcnt lgkmcnt(9)
    v_pk_add_f32 v[28:29], v[16:17], v[48:49]
    v_pk_add_f32 v[30:31], v[16:17], v[50:51]
    v_pk_add_f32 v[32:33], v[16:17], v[52:53]
    v_pk_add_f32 v[34:35], v[16:17], v[54:55]
    v_pk_add_f32 v[36:37], v[16:17], v[56:57]
    v_pk_add_f32 v[38:39], v[16:17], v[58:59]
    s_waitcnt lgkmcnt(6)
    v_pk_add_f32 v[28:29], v[28:29], v[68:69]
    v_pk_add_f32 v[30:31], v[30:31], v[70:71]
    v_pk_add_f32 v[32:33], v[32:33], v[72:73]
    v_pk_add_f32 v[34:35], v[34:35], v[74:75]
    v_pk_add_f32 v[36:37], v[36:37], v[76:77]
    v_pk_add_f32 v[38:39], v[38:39], v[78:79]
    s_waitcnt lgkmcnt(3)
    v_pk_add_f32 v[28:29], v[28:29], v[88:89]
    v_pk_add_f32 v[30:31], v[30:31], v[90:91]
    v_pk_add_f32 v[32:33], v[32:33], v[92:93]
    v_pk_add_f32 v[34:35], v[34:35], v[94:95]
    v_pk_add_f32 v[36:37], v[36:37], v[96:97]
    v_pk_add_f32 v[38:39], v[38:39], v[98:99]
    s_waitcnt lgkmcnt(0)
    v_pk_add_f32 v[28:29], v[28:29], v[108:109]
    v_pk_add_f32 v[30:31], v[30:31], v[110:111]
    v_pk_add_f32 v[32:33], v[32:33], v[112:113]
    v_pk_add_f32 v[34:35], v[34:35], v[114:115]
    v_pk_add_f32 v[36:37], v[36:37], v[116:117]
    v_pk_add_f32 v[38:39], v[38:39], v[118:119]
    v_cvt_pk_bf16_f32 v48, v28, v29
    v_cvt_pk_bf16_f32 v49, v30, v31
    v_cvt_pk_bf16_f32 v50, v32, v33
    v_cvt_pk_bf16_f32 v51, v34, v35
    v_cvt_pk_bf16_f32 v52, v36, v37
    v_cvt_pk_bf16_f32 v53, v38, v39
    v_lshlrev_b32 v28, 16, v48
    v_and_b32 v29, 0xffff0000, v48
    v_lshlrev_b32 v30, 16, v49
    v_and_b32 v31, 0xffff0000, v49
    v_lshlrev_b32 v32, 16, v50
    v_and_b32 v33, 0xffff0000, v50
    v_lshlrev_b32 v34, 16, v51
    v_and_b32 v35, 0xffff0000, v51
    v_lshlrev_b32 v36, 16, v52
    v_and_b32 v37, 0xffff0000, v52
    v_lshlrev_b32 v38, 16, v53
    v_and_b32 v39, 0xffff0000, v53
    v_mov_b32 v2, 163772
    s_mov_b32 s99, 0
PK_PW:
    ds_read_b32 v3, v2
    s_add_u32 s99, s99, 1
    s_cmp_gt_u32 s99, 2097152
    s_waitcnt lgkmcnt(0)
    v_cmp_gt_u32 vcc, 4, v3
    s_cbranch_scc1 PK_PW_OK
    s_cbranch_vccnz PK_PW
PK_PW_OK:
    ds_read_b64 v[18:19], v15 offset:0
    ds_read_b64 v[20:21], v15 offset:512
    ds_read_b64 v[22:23], v15 offset:1024
    s_waitcnt lgkmcnt(0)
    v_lshlrev_b32 v108, 16, v18
    v_and_b32 v109, 0xffff0000, v18
    v_pk_add_f32 v[28:29], v[28:29], v[108:109]
    v_cvt_pk_bf16_f32 v60, v28, v29
    v_lshlrev_b32 v110, 16, v19
    v_and_b32 v111, 0xffff0000, v19
    v_pk_add_f32 v[30:31], v[30:31], v[110:111]
    v_cvt_pk_bf16_f32 v61, v30, v31
    buffer_store_dwordx2 v[60:61], v10, s[72:75], 0 offen offset:0
    v_lshlrev_b32 v112, 16, v20
    v_and_b32 v113, 0xffff0000, v20
    v_pk_add_f32 v[32:33], v[32:33], v[112:113]
    v_cvt_pk_bf16_f32 v62, v32, v33
    v_lshlrev_b32 v114, 16, v21
    v_and_b32 v115, 0xffff0000, v21
    v_pk_add_f32 v[34:35], v[34:35], v[114:115]
    v_cvt_pk_bf16_f32 v63, v34, v35
    buffer_store_dwordx2 v[62:63], v10, s[72:75], 0 offen offset:32
    v_lshlrev_b32 v116, 16, v22
    v_and_b32 v117, 0xffff0000, v22
    v_pk_add_f32 v[36:37], v[36:37], v[116:117]
    v_cvt_pk_bf16_f32 v64, v36, v37
    v_lshlrev_b32 v118, 16, v23
    v_and_b32 v119, 0xffff0000, v23
    v_pk_add_f32 v[38:39], v[38:39], v[118:119]
    v_cvt_pk_bf16_f32 v65, v38, v39
    buffer_store_dwordx2 v[64:65], v10, s[72:75], 0 offen offset:64
    s_or_b32 s90, s2, s3
    s_cmp_lg_u32 s90, 0
    s_cbranch_scc1 PK_NOEP
    s_mov_b32 s90, 9846784
    v_mov_b32 v2, s80
    v_mov_b32 v3, s90
    s_mov_b64 exec, 1
    buffer_store_dword v2, v3, s[76:79], 0 offen sc1
    s_mov_b64 exec, -1
PK_NOEP:
    s_endpgm
PK_H:
    s_cmp_ge_u32 s2, 160
    s_cselect_b32 s97, 1073741824, 0
    s_mul_hi_u32 s81, s2, 0x33333334
    s_mul_i32 s82, s81, 5
    s_sub_u32 s82, s2, s82
    s_lshl_b32 s90, s81, 2
    s_add_u32 s90, s90, s3
    s_mul_i32 s90, s90, 20480
    s_lshl_b32 s91, s82, 8
    s_add_u32 s90, s90, s91
    s_add_u32 s90, s90, s97
    v_add_u32 v11, s90, v3
    v_subrev_u32 v10, 3840, v11
    v_add_u32 v12, 5120, v11
    v_add_u32 v13, 10240, v11
    v_add_u32 v14, 15360, v11
    s_lshl_b32 s91, s82, 10
    v_lshl_add_u32 v15, v1, 4, s91
    s_mov_b32 s76, s26
    s_mov_b32 s77, s27
    s_mov_b32 s78, 10113024
    s_mov_b32 s79, 0x00020000
    buffer_load_dword v9, v8, s[76:79], 0 offen sc1
    s_mov_b32 s36, s6
    s_mov_b32 s37, s7
    s_mov_b32 s38, 2621440
    s_mov_b32 s39, 0x00020000
    s_mov_b32 s40, s8
    s_mov_b32 s41, s9
    s_mov_b32 s42, 2621440
    s_mov_b32 s43, 0x00020000
    s_mov_b32 s44, s10
    s_mov_b32 s45, s11
    s_mov_b32 s46, 5120
    s_mov_b32 s47, 0x00020000
    s_mov_b32 s48, s12
    s_mov_b32 s49, s13
    s_mov_b32 s50, 2621440
    s_mov_b32 s51, 0x00020000
    s_mov_b32 s52, s14
    s_mov_b32 s53, s15
    s_mov_b32 s54, 1280
    s_mov_b32 s55, 0x00020000
    s_mov_b32 s64, s20
    s_mov_b32 s65, s21
    s_mov_b32 s66, 6291456
    s_mov_b32 s67, 0x00020000
    s_mov_b32 s68, s22
    s_mov_b32 s69, s23
    s_mov_b32 s70, 4096
    s_mov_b32 s71, 0x00020000
    s_mov_b32 s72, s24
    s_mov_b32 s73, s25
    s_mov_b32 s74, 2621440
    s_mov_b32 s75, 0x00020000
    s_mov_b32 s60, s18
    s_mov_b32 s61, s19
    s_mov_b32 s62, 3072
    s_mov_b32 s63, 0x00020000
    s_lshr_b32 s90, s2, 3
    s_mul_hi_u32 s90, s90, 0x33333334
    s_bfe_u32 s91, s2, 0x20001
    s_mul_i32 s91, s91, 6
    s_add_u32 s90, s90, s91
    s_lshr_b32 s90, s2, 3
    s_mul_hi_u32 s90, s90, 0x1999999a
    s_and_b32 s91, s2, 7
    s_mul_i32 s91, s91, 3
    s_add_u32 s90, s90, s91
    s_lshl_b32 s90, s90, 7
    v_and_b32 v125, 124, v3
    buffer_load_dword v126, v125, s[60:63], s90 offen
    v_add_u32 v125, 153472, v125
    s_mul_i32 s90, s3, 2688
    s_add_u32 s90, s90, 114688
    v_add_u32 v4, s90, v3
    v_lshrrev_b32 v5, 4, v1
    v_lshlrev_b32 v5, 5, v5
    v_and_b32 v2, 3, v1
    v_lshl_add_u32 v5, v2, 3, v5
    v_bfe_u32 v2, v1, 2, 2
    v_mul_u32_u24 v2, 1344, v2
    v_add_u32 v5, v5, v2
    s_lshl_b32 s90, s3, 7
    s_add_u32 s90, s90, 114688
    v_add_u32 v5, s90, v5
    s_mul_i32 s90, s2, 10240
    s_lshl_b32 s91, s3, 10
    s_add_u32 s90, s90, s91
    v_lshl_add_u32 v6, v1, 4, s90
    v_add_u32 v7, 4096, v6
    s_cmp_ge_u32 s3, 2
    s_cselect_b32 s91, 1073741824, 8192
    v_add_u32 v8, s91, v6
    s_lshl_b32 s90, s2, 2
    s_add_u32 s90, s90, s3
    s_lshl_b32 s90, s90, 4
    s_add_u32 s90, s90, 9830400
    v_mov_b32 v90, s90
    s_lshl_b32 s90, s3, 8
    s_add_u32 s90, s90, s2
    s_lshl_b32 s90, s90, 4
    s_add_u32 s85, s90, 9850880
    s_waitcnt vmcnt(11)
    v_lshlrev_b32 v26, 16, v16
    v_and_b32 v27, 0xffff0000, v16
    v_readfirstlane_b32 s28, v26
    s_waitcnt vmcnt(10)
    v_lshlrev_b32 v28, 16, v17
    v_and_b32 v29, 0xffff0000, v17
    s_waitcnt vmcnt(9)
    v_lshlrev_b32 v30, 16, v18
    v_and_b32 v31, 0xffff0000, v18
    s_mov_b32 s29, s28
    s_waitcnt vmcnt(8)
    v_lshlrev_b32 v32, 16, v19
    v_and_b32 v33, 0xffff0000, v19
    s_waitcnt vmcnt(7)
    v_lshlrev_b32 v34, 16, v20
    v_and_b32 v35, 0xffff0000, v20
    s_waitcnt vmcnt(6)
    v_lshlrev_b32 v36, 16, v21
    v_and_b32 v37, 0xffff0000, v21
    v_readfirstlane_b32 s30, v36
    s_waitcnt vmcnt(5)
    v_lshlrev_b32 v38, 16, v22
    v_and_b32 v39, 0xffff0000, v22
    s_waitcnt vmcnt(4)
    v_lshlrev_b32 v40, 16, v23
    v_and_b32 v41, 0xffff0000, v23
    s_mov_b32 s31, s30
    s_waitcnt vmcnt(3)
    v_lshlrev_b32 v42, 16, v24
    v_and_b32 v43, 0xffff0000, v24
    s_waitcnt vmcnt(2)
    v_lshlrev_b32 v44, 16, v25
    v_and_b32 v45, 0xffff0000, v25
    v_mov_b32 v91, 0x3acccccd
    v_pk_add_f32 v[46:47], v[26:27], s[28:29] neg_lo:[0,1] neg_hi:[0,1]
    v_pk_add_f32 v[56:57], v[36:37], s[30:31] neg_lo:[0,1] neg_hi:[0,1]
    v_pk_add_f32 v[48:49], v[28:29], s[28:29] neg_lo:[0,1] neg_hi:[0,1]
    v_pk_add_f32 v[58:59], v[38:39], s[30:31] neg_lo:[0,1] neg_hi:[0,1]
    v_pk_add_f32 v[50:51], v[30:31], s[28:29] neg_lo:[0,1] neg_hi:[0,1]
    v_pk_add_f32 v[60:61], v[40:41], s[30:31] neg_lo:[0,1] neg_hi:[0,1]
    v_pk_add_f32 v[52:53], v[32:33], s[28:29] neg_lo:[0,1] neg_hi:[0,1]
    v_pk_add_f32 v[62:63], v[42:43], s[30:31] neg_lo:[0,1] neg_hi:[0,1]
    v_pk_add_f32 v[54:55], v[34:35], s[28:29] neg_lo:[0,1] neg_hi:[0,1]
    v_pk_add_f32 v[64:65], v[44:45], s[30:31] neg_lo:[0,1] neg_hi:[0,1]
    v_pk_mul_f32 v[68:69], v[46:47], v[46:47]
    v_pk_mul_f32 v[72:73], v[56:57], v[56:57]
    v_pk_add_f32 v[66:67], v[46:47], v[48:49]
    v_pk_add_f32 v[70:71], v[56:57], v[58:59]
    v_pk_fma_f32 v[68:69], v[48:49], v[48:49], v[68:69]
    v_pk_fma_f32 v[72:73], v[58:59], v[58:59], v[72:73]
    v_pk_fma_f32 v[68:69], v[50:51], v[50:51], v[68:69]
    v_pk_fma_f32 v[72:73], v[60:61], v[60:61], v[72:73]
    v_pk_add_f32 v[66:67], v[66:67], v[50:51]
    v_pk_add_f32 v[70:71], v[70:71], v[60:61]
    v_pk_fma_f32 v[68:69], v[52:53], v[52:53], v[68:69]
    v_pk_fma_f32 v[72:73], v[62:63], v[62:63], v[72:73]
    v_pk_add_f32 v[66:67], v[66:67], v[52:53]
    v_pk_add_f32 v[70:71], v[70:71], v[62:63]
    v_pk_fma_f32 v[68:69], v[54:55], v[54:55], v[68:69]
    v_pk_fma_f32 v[72:73], v[64:65], v[64:65], v[72:73]
    v_pk_add_f32 v[66:67], v[66:67], v[54:55]
    v_pk_add_f32 v[70:71], v[70:71], v[64:65]
    v_add_f32 v66, v66, v67
    v_add_f32 v70, v70, v71
    v_add_f32 v67, v68, v69
    v_add_f32 v71, v72, v73
    v_add_f32_dpp v66, v66, v66 row_shr:1 row_mask:0xf bank_mask:0xf bound_ctrl:0
    v_add_f32_dpp v70, v70, v70 row_shr:1 row_mask:0xf bank_mask:0xf bound_ctrl:0
    v_add_f32_dpp v67, v67, v67 row_shr:1 row_mask:0xf bank_mask:0xf bound_ctrl:0
    v_add_f32_dpp v71, v71, v71 row_shr:1 row_mask:0xf bank_mask:0xf bound_ctrl:0
    v_add_f32_dpp v66, v66, v66 row_shr:2 row_mask:0xf bank_mask:0xf bound_ctrl:0
    v_add_f32_dpp v70, v70, v70 row_shr:2 row_mask:0xf bank_mask:0xf bound_ctrl:0
    v_add_f32_dpp v67, v67, v67 row_shr:2 row_mask:0xf bank_mask:0xf bound_ctrl:0
    v_add_f32_dpp v71, v71, v71 row_shr:2 row_mask:0xf bank_mask:0xf bound_ctrl:0
    v_add_f32_dpp v66, v66, v66 row_shr:4 row_mask:0xf bank_mask:0xf bound_ctrl:0
    v_add_f32_dpp v70, v70, v70 row_shr:4 row_mask:0xf bank_mask:0xf bound_ctrl:0
    v_add_f32_dpp v67, v67, v67 row_shr:4 row_mask:0xf bank_mask:0xf bound_ctrl:0
    v_add_f32_dpp v71, v71, v71 row_shr:4 row_mask:0xf bank_mask:0xf bound_ctrl:0
    v_add_f32_dpp v66, v66, v66 row_shr:8 row_mask:0xf bank_mask:0xf bound_ctrl:0
    v_add_f32_dpp v70, v70, v70 row_shr:8 row_mask:0xf bank_mask:0xf bound_ctrl:0
    v_add_f32_dpp v67, v67, v67 row_shr:8 row_mask:0xf bank_mask:0xf bound_ctrl:0
    v_add_f32_dpp v71, v71, v71 row_shr:8 row_mask:0xf bank_mask:0xf bound_ctrl:0
    v_add_f32_dpp v66, v66, v66 row_bcast:15 row_mask:0xa bank_mask:0xf
    v_add_f32_dpp v70, v70, v70 row_bcast:15 row_mask:0xa bank_mask:0xf
    v_add_f32_dpp v67, v67, v67 row_bcast:15 row_mask:0xa bank_mask:0xf
    v_add_f32_dpp v71, v71, v71 row_bcast:15 row_mask:0xa bank_mask:0xf
    v_add_f32_dpp v66, v66, v66 row_bcast:31 row_mask:0xc bank_mask:0xf
    v_add_f32_dpp v70, v70, v70 row_bcast:31 row_mask:0xc bank_mask:0xf
    v_add_f32_dpp v67, v67, v67 row_bcast:31 row_mask:0xc bank_mask:0xf
    v_add_f32_dpp v71, v71, v71 row_bcast:31 row_mask:0xc bank_mask:0xf
    v_readlane_b32 s90, v66, 63
    v_readlane_b32 s92, v70, 63
    v_readlane_b32 s91, v67, 63
    v_readlane_b32 s93, v71, 63
    v_mul_f32 v80, s90, v91
    v_mul_f32 v88, s92, v91
    v_mul_f32 v81, s91, v91
    v_mul_f32 v89, s93, v91
    v_fma_f32 v81, -v80, v80, v81
    v_fma_f32 v89, -v88, v88, v89
    v_max_f32 v81, 0, v81
    v_max_f32 v89, 0, v89
    v_add_f32 v80, s28, v80
    v_add_f32 v88, s30, v88
    v_cvt_pk_bf16_f32 v80, v80, v81
    v_cvt_pk_bf16_f32 v88, v88, v89
    v_lshlrev_b32 v74, 16, v80
    v_lshlrev_b32 v82, 16, v88
    v_and_b32 v81, 0xffff0000, v80
    v_and_b32 v89, 0xffff0000, v88
    v_add_f32 v81, 0x3727c5ac, v81
    v_add_f32 v89, 0x3727c5ac, v89
    v_cvt_pk_bf16_f32 v81, v81, v81
    v_cvt_pk_bf16_f32 v89, v89, v89
    v_lshlrev_b32 v81, 16, v81
    v_lshlrev_b32 v89, 16, v89
    v_sqrt_f32 v81, v81
    v_sqrt_f32 v89, v89
    v_cvt_pk_bf16_f32 v81, v81, v81
    v_cvt_pk_bf16_f32 v89, v89, v89
    v_lshlrev_b32 v81, 16, v81
    v_lshlrev_b32 v89, 16, v89
    v_rcp_f32 v75, v81
    v_rcp_f32 v83, v89
    v_mul_f32 v78, v74, v75
    v_mul_f32 v86, v82, v83
    v_mov_b32 v76, v75
    v_mov_b32 v84, v83
    v_mul_f32 v79, v74, v75
    v_mul_f32 v87, v82, v83
    v_mov_b32 v77, v75
    v_mov_b32 v85, v83
    s_mov_b64 exec, 1
    buffer_store_dwordx2 v[74:75], v90, s[76:79], 0 offen sc1
    buffer_store_dwordx2 v[82:83], v90, s[76:79], 0 offen offset:8 sc1
    s_mov_b64 exec, -1
    v_pk_fma_f32 v[46:47], v[26:27], v[76:77], v[78:79] neg_lo:[0,0,1] neg_hi:[0,0,1]
    v_pk_fma_f32 v[56:57], v[36:37], v[84:85], v[86:87] neg_lo:[0,0,1] neg_hi:[0,0,1]
    v_pk_fma_f32 v[48:49], v[28:29], v[76:77], v[78:79] neg_lo:[0,0,1] neg_hi:[0,0,1]
    v_pk_fma_f32 v[58:59], v[38:39], v[84:85], v[86:87] neg_lo:[0,0,1] neg_hi:[0,0,1]
    v_pk_fma_f32 v[50:51], v[30:31], v[76:77], v[78:79] neg_lo:[0,0,1] neg_hi:[0,0,1]
    v_pk_fma_f32 v[60:61], v[40:41], v[84:85], v[86:87] neg_lo:[0,0,1] neg_hi:[0,0,1]
    v_pk_fma_f32 v[52:53], v[32:33], v[76:77], v[78:79] neg_lo:[0,0,1] neg_hi:[0,0,1]
    v_pk_fma_f32 v[62:63], v[42:43], v[84:85], v[86:87] neg_lo:[0,0,1] neg_hi:[0,0,1]
    v_pk_fma_f32 v[54:55], v[34:35], v[76:77], v[78:79] neg_lo:[0,0,1] neg_hi:[0,0,1]
    v_pk_fma_f32 v[64:65], v[44:45], v[84:85], v[86:87] neg_lo:[0,0,1] neg_hi:[0,0,1]
    v_cvt_pk_bf16_f32 v16, v46, v47
    v_cvt_pk_bf16_f32 v21, v56, v57
    v_cvt_pk_bf16_f32 v17, v48, v49
    v_cvt_pk_bf16_f32 v22, v58, v59
    v_cvt_pk_bf16_f32 v18, v50, v51
    v_cvt_pk_bf16_f32 v23, v60, v61
    v_cvt_pk_bf16_f32 v19, v52, v53
    v_cvt_pk_bf16_f32 v24, v62, v63
    v_cvt_pk_bf16_f32 v20, v54, v55
    v_cvt_pk_bf16_f32 v25, v64, v65
    v_lshlrev_b32 v26, 16, v16
    v_lshlrev_b32 v36, 16, v21
    v_and_b32 v27, 0xffff0000, v16
    v_and_b32 v37, 0xffff0000, v21
    v_lshlrev_b32 v28, 16, v17
    v_lshlrev_b32 v38, 16, v22
    v_and_b32 v29, 0xffff0000, v17
    v_and_b32 v39, 0xffff0000, v22
    v_lshlrev_b32 v30, 16, v18
    v_lshlrev_b32 v40, 16, v23
    v_and_b32 v31, 0xffff0000, v18
    v_and_b32 v41, 0xffff0000, v23
    v_lshlrev_b32 v32, 16, v19
    v_lshlrev_b32 v42, 16, v24
    v_and_b32 v33, 0xffff0000, v19
    v_and_b32 v43, 0xffff0000, v24
    v_lshlrev_b32 v34, 16, v20
    v_lshlrev_b32 v44, 16, v25
    v_and_b32 v35, 0xffff0000, v20
    v_and_b32 v45, 0xffff0000, v25
    v_pk_mul_f32 v[68:69], v[26:27], v[26:27]
    v_pk_mul_f32 v[72:73], v[36:37], v[36:37]
    v_pk_add_f32 v[66:67], v[26:27], v[28:29]
    v_pk_add_f32 v[70:71], v[36:37], v[38:39]
    v_pk_fma_f32 v[68:69], v[28:29], v[28:29], v[68:69]
    v_pk_fma_f32 v[72:73], v[38:39], v[38:39], v[72:73]
    v_pk_fma_f32 v[68:69], v[30:31], v[30:31], v[68:69]
    v_pk_fma_f32 v[72:73], v[40:41], v[40:41], v[72:73]
    v_pk_add_f32 v[66:67], v[66:67], v[30:31]
    v_pk_add_f32 v[70:71], v[70:71], v[40:41]
    v_pk_fma_f32 v[68:69], v[32:33], v[32:33], v[68:69]
    v_pk_fma_f32 v[72:73], v[42:43], v[42:43], v[72:73]
    v_pk_add_f32 v[66:67], v[66:67], v[32:33]
    v_pk_add_f32 v[70:71], v[70:71], v[42:43]
    v_pk_fma_f32 v[68:69], v[34:35], v[34:35], v[68:69]
    v_pk_fma_f32 v[72:73], v[44:45], v[44:45], v[72:73]
    v_pk_add_f32 v[66:67], v[66:67], v[34:35]
    v_pk_add_f32 v[70:71], v[70:71], v[44:45]
    v_add_f32 v66, v66, v67
    v_add_f32 v70, v70, v71
    v_add_f32 v67, v68, v69
    v_add_f32 v71, v72, v73
    v_add_f32_dpp v66, v66, v66 row_shr:1 row_mask:0xf bank_mask:0xf bound_ctrl:0
    v_add_f32_dpp v70, v70, v70 row_shr:1 row_mask:0xf bank_mask:0xf bound_ctrl:0
    v_add_f32_dpp v67, v67, v67 row_shr:1 row_mask:0xf bank_mask:0xf bound_ctrl:0
    v_add_f32_dpp v71, v71, v71 row_shr:1 row_mask:0xf bank_mask:0xf bound_ctrl:0
    v_add_f32_dpp v66, v66, v66 row_shr:2 row_mask:0xf bank_mask:0xf bound_ctrl:0
    v_add_f32_dpp v70, v70, v70 row_shr:2 row_mask:0xf bank_mask:0xf bound_ctrl:0
    v_add_f32_dpp v67, v67, v67 row_shr:2 row_mask:0xf bank_mask:0xf bound_ctrl:0
    v_add_f32_dpp v71, v71, v71 row_shr:2 row_mask:0xf bank_mask:0xf bound_ctrl:0
    v_add_f32_dpp v66, v66, v66 row_shr:4 row_mask:0xf bank_mask:0xf bound_ctrl:0
    v_add_f32_dpp v70, v70, v70 row_shr:4 row_mask:0xf bank_mask:0xf bound_ctrl:0
    v_add_f32_dpp v67, v67, v67 row_shr:4 row_mask:0xf bank_mask:0xf bound_ctrl:0
    v_add_f32_dpp v71, v71, v71 row_shr:4 row_mask:0xf bank_mask:0xf bound_ctrl:0
    v_add_f32_dpp v66, v66, v66 row_shr:8 row_mask:0xf bank_mask:0xf bound_ctrl:0
    v_add_f32_dpp v70, v70, v70 row_shr:8 row_mask:0xf bank_mask:0xf bound_ctrl:0
    v_add_f32_dpp v67, v67, v67 row_shr:8 row_mask:0xf bank_mask:0xf bound_ctrl:0
    v_add_f32_dpp v71, v71, v71 row_shr:8 row_mask:0xf bank_mask:0xf bound_ctrl:0
    v_add_f32_dpp v66, v66, v66 row_bcast:15 row_mask:0xa bank_mask:0xf
    v_add_f32_dpp v70, v70, v70 row_bcast:15 row_mask:0xa bank_mask:0xf
    v_add_f32_dpp v67, v67, v67 row_bcast:15 row_mask:0xa bank_mask:0xf
    v_add_f32_dpp v71, v71, v71 row_bcast:15 row_mask:0xa bank_mask:0xf
    v_add_f32_dpp v66, v66, v66 row_bcast:31 row_mask:0xc bank_mask:0xf
    v_add_f32_dpp v70, v70, v70 row_bcast:31 row_mask:0xc bank_mask:0xf
    v_add_f32_dpp v67, v67, v67 row_bcast:31 row_mask:0xc bank_mask:0xf
    v_add_f32_dpp v71, v71, v71 row_bcast:31 row_mask:0xc bank_mask:0xf
    v_readlane_b32 s90, v66, 63
    v_readlane_b32 s92, v70, 63
    v_readlane_b32 s91, v67, 63
    v_readlane_b32 s93, v71, 63
    v_mul_f32 v80, s90, v91
    v_mul_f32 v88, s92, v91
    v_mul_f32 v81, s91, v91
    v_mul_f32 v89, s93, v91
    v_fma_f32 v81, -v80, v80, v81
    v_fma_f32 v89, -v88, v88, v89
    v_max_f32 v81, 0, v81
    v_max_f32 v89, 0, v89
    v_cvt_pk_bf16_f32 v80, v80, v81
    v_cvt_pk_bf16_f32 v88, v88, v89
    v_lshlrev_b32 v74, 16, v80
    v_lshlrev_b32 v82, 16, v88
    v_and_b32 v81, 0xffff0000, v80
    v_and_b32 v89, 0xffff0000, v88
    v_add_f32 v81, 0x3727c5ac, v81
    v_add_f32 v89, 0x3727c5ac, v89
    v_cvt_pk_bf16_f32 v81, v81, v81
    v_cvt_pk_bf16_f32 v89, v89, v89
    v_lshlrev_b32 v81, 16, v81
    v_lshlrev_b32 v89, 16, v89
    v_sqrt_f32 v81, v81
    v_sqrt_f32 v89, v89
    v_cvt_pk_bf16_f32 v81, v81, v81
    v_cvt_pk_bf16_f32 v89, v89, v89
    v_lshlrev_b32 v81, 16, v81
    v_lshlrev_b32 v89, 16, v89
    v_rcp_f32 v75, v81
    v_rcp_f32 v83, v89
    v_mul_f32 v78, v74, v75
    v_mul_f32 v86, v82, v83
    v_mov_b32 v76, v75
    v_mov_b32 v84, v83
    v_mul_f32 v79, v74, v75
    v_mul_f32 v87, v82, v83
    v_mov_b32 v77, v75
    v_mov_b32 v85, v83
    v_pk_fma_f32 v[46:47], v[26:27], v[76:77], v[78:79] neg_lo:[0,0,1] neg_hi:[0,0,1]
    v_pk_fma_f32 v[56:57], v[36:37], v[84:85], v[86:87] neg_lo:[0,0,1] neg_hi:[0,0,1]
    v_pk_fma_f32 v[48:49], v[28:29], v[76:77], v[78:79] neg_lo:[0,0,1] neg_hi:[0,0,1]
    v_pk_fma_f32 v[58:59], v[38:39], v[84:85], v[86:87] neg_lo:[0,0,1] neg_hi:[0,0,1]
    v_pk_fma_f32 v[50:51], v[30:31], v[76:77], v[78:79] neg_lo:[0,0,1] neg_hi:[0,0,1]
    v_pk_fma_f32 v[60:61], v[40:41], v[84:85], v[86:87] neg_lo:[0,0,1] neg_hi:[0,0,1]
    v_pk_fma_f32 v[52:53], v[32:33], v[76:77], v[78:79] neg_lo:[0,0,1] neg_hi:[0,0,1]
    v_pk_fma_f32 v[62:63], v[42:43], v[84:85], v[86:87] neg_lo:[0,0,1] neg_hi:[0,0,1]
    v_pk_fma_f32 v[54:55], v[34:35], v[76:77], v[78:79] neg_lo:[0,0,1] neg_hi:[0,0,1]
    v_pk_fma_f32 v[64:65], v[44:45], v[84:85], v[86:87] neg_lo:[0,0,1] neg_hi:[0,0,1]
    v_cvt_pk_bf16_f32 v16, v46, v47
    v_cvt_pk_bf16_f32 v21, v56, v57
    ds_write_b32 v4, v16 offset:0
    ds_write_b32 v4, v21 offset:1344
    v_cvt_pk_bf16_f32 v17, v48, v49
    v_cvt_pk_bf16_f32 v22, v58, v59
    ds_write_b32 v4, v17 offset:256
    ds_write_b32 v4, v22 offset:1600
    v_cvt_pk_bf16_f32 v18, v50, v51
    v_cvt_pk_bf16_f32 v23, v60, v61
    ds_write_b32 v4, v18 offset:512
    ds_write_b32 v4, v23 offset:1856
    v_cvt_pk_bf16_f32 v19, v52, v53
    v_cvt_pk_bf16_f32 v24, v62, v63
    ds_write_b32 v4, v19 offset:768
    ds_write_b32 v4, v24 offset:2112
    v_cvt_pk_bf16_f32 v20, v54, v55
    v_cvt_pk_bf16_f32 v25, v64, v65
    ds_write_b32 v4, v20 offset:1024
    ds_write_b32 v4, v25 offset:2368
    s_waitcnt vmcnt(2)
    ds_write_b32 v125, v126
    v_readfirstlane_b32 s80, v9
    s_nop 3
    s_mul_i32 s80, s80, 1664525
    s_add_u32 s80, s80, 1013904223
    v_mov_b32 v2, 163716
    v_mov_b32 v3, 1
    s_waitcnt lgkmcnt(0)
    s_mov_b64 exec, 1
    ds_add_u32 v2, v3
    s_mov_b64 exec, -1
    v_mov_b32 v2, 163716
    s_mov_b32 s99, 0
PK_HB1:
    ds_read_b32 v3, v2
    s_add_u32 s99, s99, 1
    s_cmp_gt_u32 s99, 2097152
    s_waitcnt lgkmcnt(0)
    v_cmp_gt_u32 vcc, 4, v3
    s_cbranch_scc1 PK_HB1_OK
    s_cbranch_vccnz PK_HB1
PK_HB1_OK:
    ds_read_b64_tr_b16 v[26:27], v5 offset:0
    ds_read_b64_tr_b16 v[28:29], v5 offset:5376
    ds_read_b64_tr_b16 v[30:31], v5 offset:512
    ds_read_b64_tr_b16 v[32:33], v5 offset:5888
    ds_read_b64_tr_b16 v[34:35], v5 offset:1024
    ds_read_b64_tr_b16 v[36:37], v5 offset:6400
    s_waitcnt lgkmcnt(4)
    buffer_store_dwordx4 v[26:29], v6, s[76:79], 0 offen sc1
    s_waitcnt lgkmcnt(2)
    buffer_store_dwordx4 v[30:33], v7, s[76:79], 0 offen sc1
    s_waitcnt lgkmcnt(0)
    buffer_store_dwordx4 v[34:37], v8, s[76:79], 0 offen sc1
    v_and_b32 v2, 7, v1
    s_lshl_b32 s90, s3, 1
    v_xor_b32 v4, s90, v2
    v_lshlrev_b32 v4, 4, v4
    v_lshl_add_u32 v4, v1, 8, v4
    v_add_u32 v4, 125440, v4
    v_xor_b32 v5, 16, v4
    v_lshrrev_b32 v8, 3, v1
    v_lshrrev_b32 v6, 4, v1
    v_xor_b32 v6, v6, v2
    v_lshlrev_b32 v6, 4, v6
    v_lshl_add_u32 v6, v8, 7, v6
    s_lshl_b32 s90, s3, 12
    s_add_u32 s90, s90, 125440
    v_add_u32 v6, s90, v6
    v_xor_b32 v7, 64, v6
    v_lshlrev_b32 v8, 12, v8
    v_lshl_add_u32 v8, v2, 4, v8
    s_lshl_b32 s90, s82, 19
    s_lshl_b32 s91, s3, 17
    s_add_u32 s90, s90, s91
    s_lshl_b32 s91, s81, 7
    s_add_u32 s90, s90, s91
    s_add_u32 s90, s90, 2621440
    s_add_u32 s90, s90, s97
    v_add_u32 v8, s90, v8
    v_mov_b32 v2, 163736
    s_mov_b32 s99, 0
PK_EPW:
    ds_read_b32 v3, v2
    s_add_u32 s99, s99, 1
    s_cmp_gt_u32 s99, 2097152
    s_waitcnt lgkmcnt(0)
    v_cmp_gt_u32 vcc, 4, v3
    s_cbranch_scc1 PK_EPW_OK
    s_cbranch_vccnz PK_EPW
PK_EPW_OK:
    s_waitcnt vmcnt(0)
    v_mov_b32 v2, s80
    v_mov_b32 v3, s85
    s_mov_b64 exec, 1
    buffer_store_dword v2, v3, s[76:79], 0 offen sc1
    s_mov_b64 exec, -1
    s_cmp_lg_u32 s97, 0
    s_cbranch_scc1 PK_KVL_SKIP
    buffer_load_dwordx4 a[36:39], v15, s[44:47], 0 offen
    buffer_load_dword a0, v10, s[36:39], 0 offen offset:0
    buffer_load_dword a1, v10, s[36:39], 0 offen offset:1280
    buffer_load_dword a2, v10, s[36:39], 0 offen offset:2560
    buffer_load_dword a3, v11, s[36:39], 0 offen offset:0
    buffer_load_dword a4, v11, s[36:39], 0 offen offset:1280
    buffer_load_dword a5, v11, s[36:39], 0 offen offset:2560
    buffer_load_dword a6, v11, s[36:39], 0 offen offset:3840
    buffer_load_dword a7, v12, s[36:39], 0 offen offset:0
    buffer_load_dword a8, v12, s[36:39], 0 offen offset:1280
    buffer_load_dword a9, v12, s[36:39], 0 offen offset:2560
    buffer_load_dword a10, v12, s[36:39], 0 offen offset:3840
    buffer_load_dword a11, v13, s[36:39], 0 offen offset:0
    buffer_load_dword a12, v13, s[36:39], 0 offen offset:1280
    buffer_load_dword a13, v13, s[36:39], 0 offen offset:2560
    buffer_load_dword a14, v13, s[36:39], 0 offen offset:3840
    buffer_load_dword a15, v14, s[36:39], 0 offen offset:0
    buffer_load_dword a16, v14, s[36:39], 0 offen offset:1280
    buffer_load_dword a17, v14, s[36:39], 0 offen offset:2560
    buffer_load_dword a18, v14, s[36:39], 0 offen offset:3840
    buffer_load_dword a19, v11, s[40:43], 0 offen offset:0
    buffer_load_dword a20, v11, s[40:43], 0 offen offset:1280
    buffer_load_dword a21, v11, s[40:43], 0 offen offset:2560
    buffer_load_dword a22, v11, s[40:43], 0 offen offset:3840
    buffer_load_dword a23, v12, s[40:43], 0 offen offset:0
    buffer_load_dword a24, v12, s[40:43], 0 offen offset:1280
    buffer_load_dword a25, v12, s[40:43], 0 offen offset:2560
    buffer_load_dword a26, v12, s[40:43], 0 offen offset:3840
    buffer_load_dword a27, v13, s[40:43], 0 offen offset:0
    buffer_load_dword a28, v13, s[40:43], 0 offen offset:1280
    buffer_load_dword a29, v13, s[40:43], 0 offen offset:2560
    buffer_load_dword a30, v13, s[40:43], 0 offen offset:3840
    buffer_load_dword a31, v14, s[40:43], 0 offen offset:0
    buffer_load_dword a32, v14, s[40:43], 0 offen offset:1280
    buffer_load_dword a33, v14, s[40:43], 0 offen offset:2560
    buffer_load_dword a34, v14, s[40:43], 0 offen offset:3840
PK_KVL_SKIP:
    s_setprio 0
    s_lshl_b32 s90, s82, 2
    s_add_u32 s90, s90, s3
    s_lshl_b32 s90, s90, 5
    s_add_u32 s90, s90, s81
    s_lshl_b32 s90, s90, 4
    s_add_u32 s90, s90, 9916416
    s_add_u32 s85, s90, s97
    s_lshl_b32 s94, s2, 1
    s_mul_i32 s90, s2, 3
    s_sub_u32 s90, s90, 128
    s_cmp_ge_u32 s2, 128
    s_cselect_b32 s94, s90, s94
    s_cselect_b32 s90, 3, 2
    s_add_u32 s94, s94, s3
    s_cmp_lt_u32 s3, s90
    s_cselect_b32 s94, s94, 65536
    s_min_u32 s90, s94, 639
    s_lshl_b32 s90, s90, 12
    s_add_u32 s30, s48, s90
    s_addc_u32 s31, s49, 0
    s_load_dword s29, s[30:31], 0
    s_load_dword s29, s[30:31], 128
    s_load_dword s29, s[30:31], 256
    s_load_dword s29, s[30:31], 384
    s_load_dword s29, s[30:31], 512
    s_load_dword s29, s[30:31], 640
    s_load_dword s29, s[30:31], 768
    s_load_dword s29, s[30:31], 896
    s_load_dword s29, s[30:31], 1024
    s_load_dword s29, s[30:31], 1152
    s_load_dword s29, s[30:31], 1280
    s_load_dword s29, s[30:31], 1408
    s_load_dword s29, s[30:31], 1536
    s_load_dword s29, s[30:31], 1664
    s_load_dword s29, s[30:31], 1792
    s_load_dword s29, s[30:31], 1920
    s_load_dword s29, s[30:31], 2048
    s_load_dword s29, s[30:31], 2176
    s_load_dword s29, s[30:31], 2304
    s_load_dword s29, s[30:31], 2432
    s_load_dword s29, s[30:31], 2560
    s_load_dword s29, s[30:31], 2688
    s_load_dword s29, s[30:31], 2816
    s_load_dword s29, s[30:31], 2944
    s_load_dword s29, s[30:31], 3072
    s_load_dword s29, s[30:31], 3200
    s_load_dword s29, s[30:31], 3328
    s_load_dword s29, s[30:31], 3456
    s_load_dword s29, s[30:31], 3584
    s_load_dword s29, s[30:31], 3712
    s_load_dword s29, s[30:31], 3840
    s_load_dword s29, s[30:31], 3968
    s_cmp_lg_u32 s97, 0
    s_cbranch_scc1 PK_KV_SKIP
    s_waitcnt vmcnt(16)
    v_accvgpr_read_b32 v110, a36
    v_accvgpr_read_b32 v111, a37
    v_accvgpr_read_b32 v112, a38
    v_accvgpr_read_b32 v113, a39
    v_accvgpr_read_b32 v25, a0
    v_accvgpr_read_b32 v27, a1
    v_accvgpr_read_b32 v29, a2
    v_accvgpr_read_b32 v31, a3
    v_accvgpr_read_b32 v33, a4
    v_accvgpr_read_b32 v35, a5
    v_accvgpr_read_b32 v37, a6
    v_accvgpr_read_b32 v39, a7
    v_accvgpr_read_b32 v41, a8
    v_accvgpr_read_b32 v43, a9
    v_accvgpr_read_b32 v45, a10
    v_accvgpr_read_b32 v47, a11
    v_accvgpr_read_b32 v49, a12
    v_accvgpr_read_b32 v51, a13
    v_accvgpr_read_b32 v53, a14
    v_accvgpr_read_b32 v55, a15
    v_accvgpr_read_b32 v57, a16
    v_accvgpr_read_b32 v59, a17
    v_accvgpr_read_b32 v61, a18
    v_lshlrev_b32 v16, 16, v110
    v_lshlrev_b32 v17, 16, v112
    v_and_b32 v18, 0xffff0000, v110
    v_and_b32 v19, 0xffff0000, v112
    v_lshlrev_b32 v20, 16, v111
    v_lshlrev_b32 v21, 16, v113
    v_and_b32 v22, 0xffff0000, v111
    v_and_b32 v23, 0xffff0000, v113
    v_lshlrev_b32 v24, 16, v25
    v_and_b32 v25, 0xffff0000, v25
    v_lshlrev_b32 v26, 16, v27
    v_and_b32 v27, 0xffff0000, v27
    v_lshlrev_b32 v28, 16, v29
    v_and_b32 v29, 0xffff0000, v29
    v_lshlrev_b32 v30, 16, v31
    v_and_b32 v31, 0xffff0000, v31
    v_lshlrev_b32 v32, 16, v33
    v_and_b32 v33, 0xffff0000, v33
    v_lshlrev_b32 v34, 16, v35
    v_and_b32 v35, 0xffff0000, v35
    v_lshlrev_b32 v36, 16, v37
    v_and_b32 v37, 0xffff0000, v37
    v_lshlrev_b32 v38, 16, v39
    v_and_b32 v39, 0xffff0000, v39
    v_lshlrev_b32 v40, 16, v41
    v_and_b32 v41, 0xffff0000, v41
    v_lshlrev_b32 v42, 16, v43
    v_and_b32 v43, 0xffff0000, v43
    v_lshlrev_b32 v44, 16, v45
    v_and_b32 v45, 0xffff0000, v45
    v_lshlrev_b32 v46, 16, v47
    v_and_b32 v47, 0xffff0000, v47
    v_lshlrev_b32 v48, 16, v49
    v_and_b32 v49, 0xffff0000, v49
    v_lshlrev_b32 v50, 16, v51
    v_and_b32 v51, 0xffff0000, v51
    v_lshlrev_b32 v52, 16, v53
    v_and_b32 v53, 0xffff0000, v53
    v_lshlrev_b32 v54, 16, v55
    v_and_b32 v55, 0xffff0000, v55
    v_lshlrev_b32 v56, 16, v57
    v_and_b32 v57, 0xffff0000, v57
    v_lshlrev_b32 v58, 16, v59
    v_and_b32 v59, 0xffff0000, v59
    v_lshlrev_b32 v60, 16, v61
    v_and_b32 v61, 0xffff0000, v61
    v_pk_mul_f32 v[62:63], v[24:25], v[22:23]
    v_pk_mul_f32 v[64:65], v[26:27], v[22:23]
    v_pk_mul_f32 v[66:67], v[28:29], v[22:23]
    v_pk_mul_f32 v[68:69], v[30:31], v[22:23]
    v_pk_mul_f32 v[70:71], v[32:33], v[22:23]
    v_pk_mul_f32 v[72:73], v[34:35], v[22:23]
    v_pk_mul_f32 v[74:75], v[36:37], v[22:23]
    v_pk_mul_f32 v[76:77], v[38:39], v[22:23]
    v_pk_mul_f32 v[78:79], v[40:41], v[22:23]
    v_pk_mul_f32 v[80:81], v[42:43], v[22:23]
    v_pk_mul_f32 v[82:83], v[44:45], v[22:23]
    v_pk_mul_f32 v[84:85], v[46:47], v[22:23]
    v_pk_mul_f32 v[86:87], v[48:49], v[22:23]
    v_pk_mul_f32 v[88:89], v[50:51], v[22:23]
    v_pk_mul_f32 v[90:91], v[52:53], v[22:23]
    v_pk_mul_f32 v[92:93], v[54:55], v[22:23]
    v_pk_fma_f32 v[62:63], v[26:27], v[20:21], v[62:63]
    v_pk_fma_f32 v[64:65], v[28:29], v[20:21], v[64:65]
    v_pk_fma_f32 v[66:67], v[30:31], v[20:21], v[66:67]
    v_pk_fma_f32 v[68:69], v[32:33], v[20:21], v[68:69]
    v_pk_fma_f32 v[70:71], v[34:35], v[20:21], v[70:71]
    v_pk_fma_f32 v[72:73], v[36:37], v[20:21], v[72:73]
    v_pk_fma_f32 v[74:75], v[38:39], v[20:21], v[74:75]
    v_pk_fma_f32 v[76:77], v[40:41], v[20:21], v[76:77]
    v_pk_fma_f32 v[78:79], v[42:43], v[20:21], v[78:79]
    v_pk_fma_f32 v[80:81], v[44:45], v[20:21], v[80:81]
    v_pk_fma_f32 v[82:83], v[46:47], v[20:21], v[82:83]
    v_pk_fma_f32 v[84:85], v[48:49], v[20:21], v[84:85]
    v_pk_fma_f32 v[86:87], v[50:51], v[20:21], v[86:87]
    v_pk_fma_f32 v[88:89], v[52:53], v[20:21], v[88:89]
    v_pk_fma_f32 v[90:91], v[54:55], v[20:21], v[90:91]
    v_pk_fma_f32 v[92:93], v[56:57], v[20:21], v[92:93]
    v_pk_fma_f32 v[62:63], v[28:29], v[18:19], v[62:63]
    v_pk_fma_f32 v[64:65], v[30:31], v[18:19], v[64:65]
    v_pk_fma_f32 v[66:67], v[32:33], v[18:19], v[66:67]
    v_pk_fma_f32 v[68:69], v[34:35], v[18:19], v[68:69]
    v_pk_fma_f32 v[70:71], v[36:37], v[18:19], v[70:71]
    v_pk_fma_f32 v[72:73], v[38:39], v[18:19], v[72:73]
    v_pk_fma_f32 v[74:75], v[40:41], v[18:19], v[74:75]
    v_pk_fma_f32 v[76:77], v[42:43], v[18:19], v[76:77]
    v_pk_fma_f32 v[78:79], v[44:45], v[18:19], v[78:79]
    v_pk_fma_f32 v[80:81], v[46:47], v[18:19], v[80:81]
    v_pk_fma_f32 v[82:83], v[48:49], v[18:19], v[82:83]
    v_pk_fma_f32 v[84:85], v[50:51], v[18:19], v[84:85]
    v_pk_fma_f32 v[86:87], v[52:53], v[18:19], v[86:87]
    v_pk_fma_f32 v[88:89], v[54:55], v[18:19], v[88:89]
    v_pk_fma_f32 v[90:91], v[56:57], v[18:19], v[90:91]
    v_pk_fma_f32 v[92:93], v[58:59], v[18:19], v[92:93]
    v_pk_fma_f32 v[62:63], v[30:31], v[16:17], v[62:63]
    v_pk_fma_f32 v[64:65], v[32:33], v[16:17], v[64:65]
    v_pk_fma_f32 v[66:67], v[34:35], v[16:17], v[66:67]
    v_pk_fma_f32 v[68:69], v[36:37], v[16:17], v[68:69]
    v_pk_fma_f32 v[70:71], v[38:39], v[16:17], v[70:71]
    v_pk_fma_f32 v[72:73], v[40:41], v[16:17], v[72:73]
    v_pk_fma_f32 v[74:75], v[42:43], v[16:17], v[74:75]
    v_pk_fma_f32 v[76:77], v[44:45], v[16:17], v[76:77]
    v_pk_fma_f32 v[78:79], v[46:47], v[16:17], v[78:79]
    v_pk_fma_f32 v[80:81], v[48:49], v[16:17], v[80:81]
    v_pk_fma_f32 v[82:83], v[50:51], v[16:17], v[82:83]
    v_pk_fma_f32 v[84:85], v[52:53], v[16:17], v[84:85]
    v_pk_fma_f32 v[86:87], v[54:55], v[16:17], v[86:87]
    v_pk_fma_f32 v[88:89], v[56:57], v[16:17], v[88:89]
    v_pk_fma_f32 v[90:91], v[58:59], v[16:17], v[90:91]
    v_pk_fma_f32 v[92:93], v[60:61], v[16:17], v[92:93]
    s_waitcnt vmcnt(0)
    v_accvgpr_read_b32 v25, a19
    v_accvgpr_read_b32 v27, a20
    v_accvgpr_read_b32 v29, a21
    v_accvgpr_read_b32 v31, a22
    v_accvgpr_read_b32 v33, a23
    v_accvgpr_read_b32 v35, a24
    v_accvgpr_read_b32 v37, a25
    v_accvgpr_read_b32 v39, a26
    v_accvgpr_read_b32 v41, a27
    v_accvgpr_read_b32 v43, a28
    v_accvgpr_read_b32 v45, a29
    v_accvgpr_read_b32 v47, a30
    v_accvgpr_read_b32 v49, a31
    v_accvgpr_read_b32 v51, a32
    v_accvgpr_read_b32 v53, a33
    v_accvgpr_read_b32 v55, a34
    v_lshlrev_b32 v24, 16, v25
    v_and_b32 v25, 0xffff0000, v25
    v_lshlrev_b32 v26, 16, v27
    v_and_b32 v27, 0xffff0000, v27
    v_lshlrev_b32 v28, 16, v29
    v_and_b32 v29, 0xffff0000, v29
    v_lshlrev_b32 v30, 16, v31
    v_and_b32 v31, 0xffff0000, v31
    v_lshlrev_b32 v32, 16, v33
    v_and_b32 v33, 0xffff0000, v33
    v_lshlrev_b32 v34, 16, v35
    v_and_b32 v35, 0xffff0000, v35
    v_lshlrev_b32 v36, 16, v37
    v_and_b32 v37, 0xffff0000, v37
    v_lshlrev_b32 v38, 16, v39
    v_and_b32 v39, 0xffff0000, v39
    v_lshlrev_b32 v40, 16, v41
    v_and_b32 v41, 0xffff0000, v41
    v_lshlrev_b32 v42, 16, v43
    v_and_b32 v43, 0xffff0000, v43
    v_lshlrev_b32 v44, 16, v45
    v_and_b32 v45, 0xffff0000, v45
    v_lshlrev_b32 v46, 16, v47
    v_and_b32 v47, 0xffff0000, v47
    v_lshlrev_b32 v48, 16, v49
    v_and_b32 v49, 0xffff0000, v49
    v_lshlrev_b32 v50, 16, v51
    v_and_b32 v51, 0xffff0000, v51
    v_lshlrev_b32 v52, 16, v53
    v_and_b32 v53, 0xffff0000, v53
    v_lshlrev_b32 v54, 16, v55
    v_and_b32 v55, 0xffff0000, v55
    v_pk_mul_f32 v[62:63], v[62:63], v[24:25]
    v_pk_mul_f32 v[64:65], v[64:65], v[26:27]
    v_pk_mul_f32 v[66:67], v[66:67], v[28:29]
    v_pk_mul_f32 v[68:69], v[68:69], v[30:31]
    v_pk_mul_f32 v[70:71], v[70:71], v[32:33]
    v_pk_mul_f32 v[72:73], v[72:73], v[34:35]
    v_pk_mul_f32 v[74:75], v[74:75], v[36:37]
    v_pk_mul_f32 v[76:77], v[76:77], v[38:39]
    v_pk_mul_f32 v[78:79], v[78:79], v[40:41]
    v_pk_mul_f32 v[80:81], v[80:81], v[42:43]
    v_pk_mul_f32 v[82:83], v[82:83], v[44:45]
    v_pk_mul_f32 v[84:85], v[84:85], v[46:47]
    v_pk_mul_f32 v[86:87], v[86:87], v[48:49]
    v_pk_mul_f32 v[88:89], v[88:89], v[50:51]
    v_pk_mul_f32 v[90:91], v[90:91], v[52:53]
    v_pk_mul_f32 v[92:93], v[92:93], v[54:55]
    v_cvt_pk_bf16_f32 v94, v76, v74
    v_cvt_pk_bf16_f32 v95, v72, v70
    v_cvt_pk_bf16_f32 v96, v68, v66
    v_cvt_pk_bf16_f32 v97, v64, v62
    ds_write_b128 v4, v[94:97] offset:0
    v_cvt_pk_bf16_f32 v98, v77, v75
    v_cvt_pk_bf16_f32 v99, v73, v71
    v_cvt_pk_bf16_f32 v100, v69, v67
    v_cvt_pk_bf16_f32 v101, v65, v63
    ds_write_b128 v4, v[98:101] offset:128
    v_cvt_pk_bf16_f32 v102, v92, v90
    v_cvt_pk_bf16_f32 v103, v88, v86
    v_cvt_pk_bf16_f32 v104, v84, v82
    v_cvt_pk_bf16_f32 v105, v80, v78
    ds_write_b128 v5, v[102:105] offset:0
    v_cvt_pk_bf16_f32 v106, v93, v91
    v_cvt_pk_bf16_f32 v107, v89, v87
    v_cvt_pk_bf16_f32 v108, v85, v83
    v_cvt_pk_bf16_f32 v109, v81, v79
    ds_write_b128 v5, v[106:109] offset:128
    v_mov_b32 v2, 163720
    v_mov_b32 v3, 1
    s_waitcnt lgkmcnt(0)
    s_mov_b64 exec, 1
    ds_add_u32 v2, v3
    s_mov_b64 exec, -1
    v_mov_b32 v2, 163720
    s_mov_b32 s99, 0
PK_HB2:
    ds_read_b32 v3, v2
    s_add_u32 s99, s99, 1
    s_cmp_gt_u32 s99, 2097152
    s_waitcnt lgkmcnt(0)
    v_cmp_gt_u32 vcc, 4, v3
    s_cbranch_scc1 PK_HB2_OK
    s_cbranch_vccnz PK_HB2
PK_HB2_OK:
    ds_read_b128 v[94:97], v6 offset:0
    ds_read_b128 v[98:101], v7 offset:1024
    ds_read_b128 v[102:105], v6 offset:2048
    ds_read_b128 v[106:109], v7 offset:3072
    s_setprio 3
    s_mov_b32 s90, 0
    s_waitcnt lgkmcnt(3)
    buffer_store_dwordx4 v[94:97], v8, s[76:79], s90 offen sc1
    s_mov_b32 s90, 32768
    s_waitcnt lgkmcnt(2)
    buffer_store_dwordx4 v[98:101], v8, s[76:79], s90 offen sc1
    s_mov_b32 s90, 65536
    s_waitcnt lgkmcnt(1)
    buffer_store_dwordx4 v[102:105], v8, s[76:79], s90 offen sc1
    s_mov_b32 s90, 98304
    s_waitcnt lgkmcnt(0)
    buffer_store_dwordx4 v[106:109], v8, s[76:79], s90 offen sc1
PK_KV_SKIP:
    s_setprio 3
    v_mov_b32 v2, 163724
    v_mov_b32 v3, 1
    s_waitcnt lgkmcnt(0)
    s_mov_b64 exec, 1
    ds_add_u32 v2, v3
    s_mov_b64 exec, -1
    v_lshrrev_b32 v14, 4, v1
    v_and_b32 v15, 15, v1
    s_mul_i32 s95, s3, 12928
    s_add_u32 s95, s95, 114688
    s_lshr_b32 s90, s94, 5
    s_lshl_b32 s90, s90, 9
    s_add_u32 s90, s90, 9916416
    v_and_b32 v29, 31, v1
    v_lshl_add_u32 v29, v29, 4, s90
    s_lshl_b32 s90, s94, 12
    v_lshl_add_u32 v31, v1, 4, s90
    v_add_u32 v32, 2, v31
    v_add_u32 v33, 2621440, v31
    v_mov_b32 v34, s90
    s_lshl_b32 s91, s94, 1
    v_mov_b32 v36, s91
    v_lshlrev_b32 v2, 5, v15
    v_lshl_add_u32 v44, v14, 3, v2
    s_add_u32 s90, s90, 5242880
    v_add_u32 v44, s90, v44
    v_lshlrev_b32 v45, 4, v1
    v_add_u32 v46, s95, v45
    v_add_u32 v2, 4096, v45
    v_add_u32 v3, 8224, v45
    v_cmp_lt_u32 vcc, 31, v1
    v_lshl_add_u32 v38, v14, 3, v15
    v_lshlrev_b32 v38, 1, v38
    v_cndmask_b32 v45, v45, v2, vcc
    v_cmp_lt_u32 vcc, 33, v1
    v_and_b32 v2, 1, v1
    v_mul_u32_u24 v2, 4158, v2
    v_cndmask_b32 v45, v45, v3, vcc
    v_cmp_lt_u32 vcc, 35, v1
    v_sub_u32 v38, v38, v2
    v_add_u32 v38, 8768, v38
    v_cndmask_b32 v45, v45, 0, vcc
    v_add_u32 v45, s95, v45
    v_add_u32 v38, s95, v38
    v_add_u32 v39, 1024, v38
    v_add_u32 v40, 2048, v38
    v_add_u32 v41, 3072, v38
    v_lshlrev_b32 v2, 1, v15
    v_sub_u32 v2, v2, v14
    v_lshlrev_b32 v2, 4, v2
    v_add_u32 v2, 80, v2
    v_add_u32 v42, s95, v2
    v_lshrrev_b32 v2, 1, v14
    v_lshl_add_u32 v2, v15, 1, v2
    v_lshlrev_b32 v2, 4, v2
    v_and_b32 v3, 1, v14
    v_lshlrev_b32 v3, 3, v3
    v_sub_u32 v2, v2, v3
    v_add_u32 v2, 520, v2
    v_add_u32 v43, s95, v2
    s_mul_i32 s93, s83, 80
    s_lshl_b32 s90, s84, 6
    s_lshl_b32 s91, s3, 4
    s_add_u32 s90, s90, s91
    v_add_u32 v4, s90, v15
    v_mul_u32_u24 v5, 1280, v4
    v_lshl_add_u32 v5, v14, 3, v5
    s_lshl_b32 s90, s93, 1
    v_add_u32 v5, s90, v5
    v_lshlrev_b32 v126, 1, v4
    v_lshlrev_b32 v6, 3, v4
    v_add_u32 v6, 9830400, v6
    s_lshl_b32 s90, s93, 4
    s_add_u32 s90, s90, 10047488
    v_lshl_add_u32 v7, v1, 4, s90
    v_add_u32 v8, 1024, v7
    v_bfe_u32 v2, v4, 1, 2
    v_lshlrev_b32 v2, 8, v2
    v_lshrrev_b32 v3, 3, v4
    v_add_u32 v2, v2, v3
    v_cmp_lt_u32 vcc, 15, v1
    v_lshlrev_b32 v2, 4, v2
    v_add_u32 v2, 9850880, v2
    v_cndmask_b32 v8, v8, v2, vcc
    v_lshrrev_b32 v9, 1, v1
    v_lshlrev_b32 v9, 12, v9
    v_and_b32 v2, 1, v1
    v_lshl_add_u32 v9, v2, 4, v9
    s_lshl_b32 s90, s93, 12
    s_lshl_b32 s91, s84, 7
    s_add_u32 s90, s90, s91
    s_lshl_b32 s91, s3, 5
    s_add_u32 s90, s90, s91
    s_add_u32 s90, s90, 5242880
    v_add_u32 v9, s90, v9
    v_cmp_lt_u32 vcc, 31, v1
    v_add_u32 v10, 0x20000, v9
    v_add_u32 v11, 0x40000, v9
    v_mov_b32 v2, 1073741824
    v_cndmask_b32 v11, v11, v2, vcc
    s_mul_i32 s90, s3, 2560
    s_add_u32 s90, s90, 153472
    v_lshl_add_u32 v12, v1, 4, s90
    v_lshl_add_u32 v13, v1, 3, s90
    s_waitcnt vmcnt(0)
    v_mov_b32 v2, s80
    v_mov_b32 v3, s85
    s_mov_b64 exec, 1
    buffer_store_dword v2, v3, s[76:79], 0 offen sc1
    s_mov_b64 exec, -1
    s_cmp_ge_u32 s94, 640
    s_cbranch_scc1 PK_NOCONV
    v_mov_b32 v2, 163724
    s_mov_b32 s99, 0
PK_HB3:
    ds_read_b32 v3, v2
    s_add_u32 s99, s99, 1
    s_cmp_gt_u32 s99, 2097152
    s_waitcnt lgkmcnt(0)
    v_cmp_gt_u32 vcc, 4, v3
    s_cbranch_scc1 PK_HB3_OK
    s_cbranch_vccnz PK_HB3
PK_HB3_OK:
    s_add_u32 m0, s95, 4640
    buffer_load_ushort v35, v34, s[48:51], 0 offen
    buffer_load_dwordx4 v31, s[48:51], 0 offen offset:0 lds
    buffer_load_dwordx4 v31, s[48:51], 0 offen offset:1024 lds
    buffer_load_dwordx4 v31, s[48:51], 0 offen offset:2048 lds
    buffer_load_dwordx4 v31, s[48:51], 0 offen offset:3072 lds
    buffer_load_ushort v37, v36, s[52:55], 0 offen
    s_setprio 0
    s_waitcnt vmcnt(1)
    ds_read_b128 v[64:67], v46 offset:4640
    ds_read_b32 v68, v46 offset:4656
    ds_read_b128 v[72:75], v46 offset:5664
    ds_read_b32 v76, v46 offset:5680
    ds_read_b128 v[80:83], v46 offset:6688
    ds_read_b32 v84, v46 offset:6704
    ds_read_b128 v[88:91], v46 offset:7712
    ds_read_b32 v92, v46 offset:7728
    s_waitcnt lgkmcnt(6)
    v_alignbit_b32 v64, v65, v64, 16
    v_alignbit_b32 v65, v66, v65, 16
    v_alignbit_b32 v66, v67, v66, 16
    v_alignbit_b32 v67, v68, v67, 16
    ds_write_b128 v46, v[64:67] offset:8800
    s_waitcnt lgkmcnt(5)
    v_alignbit_b32 v72, v73, v72, 16
    v_alignbit_b32 v73, v74, v73, 16
    v_alignbit_b32 v74, v75, v74, 16
    v_alignbit_b32 v75, v76, v75, 16
    ds_write_b128 v46, v[72:75] offset:9824
    s_waitcnt lgkmcnt(4)
    v_alignbit_b32 v80, v81, v80, 16
    v_alignbit_b32 v81, v82, v81, 16
    v_alignbit_b32 v82, v83, v82, 16
    v_alignbit_b32 v83, v84, v83, 16
    ds_write_b128 v46, v[80:83] offset:10848
    s_waitcnt lgkmcnt(3)
    v_alignbit_b32 v88, v89, v88, 16
    v_alignbit_b32 v89, v90, v89, 16
    v_alignbit_b32 v90, v91, v90, 16
    v_alignbit_b32 v91, v92, v91, 16
    ds_write_b128 v46, v[88:91] offset:11872
    s_setprio 0
    v_mov_b32 v2, 163752
    s_mov_b32 s99, 0
PK_KW:
    s_sleep 4
    ds_read_b32 v3, v2
    s_add_u32 s99, s99, 1
    s_cmp_gt_u32 s99, 2097152
    s_waitcnt lgkmcnt(0)
    v_cmp_gt_u32 vcc, 4, v3
    s_cbranch_scc1 PK_KW_OK
    s_cbranch_vccnz PK_KW
PK_KW_OK:
    s_setprio 3
    s_mov_b32 s99, 0
PK_SPIN_KV:
    buffer_load_dword v30, v29, s[76:79], 0 offen sc1
    s_add_u32 s99, s99, 1
    s_waitcnt vmcnt(0)
    v_cmp_ne_u32 vcc, s80, v30
    s_cmp_gt_u32 s99, 20000
    s_cbranch_scc1 PK_SPIN_KV_OK
    s_cbranch_vccnz PK_SPIN_KV
PK_SPIN_KV_OK:
    buffer_load_dwordx4 v[48:51], v33, s[76:79], 0 offen offset:0 sc1
    buffer_load_dwordx4 v[52:55], v33, s[76:79], 0 offen offset:1024 sc1
    buffer_load_dwordx4 v[56:59], v33, s[76:79], 0 offen offset:2048 sc1
    buffer_load_dwordx4 v[60:63], v33, s[76:79], 0 offen offset:3072 sc1
    buffer_load_dwordx2 v[16:17], v5, s[32:35], 0 offen offset:0
    buffer_load_dwordx2 v[18:19], v5, s[32:35], 0 offen offset:32
    buffer_load_dwordx2 v[20:21], v5, s[32:35], 0 offen offset:64
    buffer_load_dwordx2 v[22:23], v5, s[32:35], 0 offen offset:96
    buffer_load_dwordx2 v[24:25], v5, s[32:35], 0 offen offset:128
    buffer_load_ushort v124, v126, s[68:71], 0 offen
    s_setprio 0
    v_mov_b32 v96, 0
    v_mov_b32 v97, 0
    v_mov_b32 v98, 0
    v_cmp_eq_u32 vcc, 35, v1
    v_lshlrev_b32 v35, 16, v35
    v_lshlrev_b32 v37, 16, v37
    v_cndmask_b32 v99, 0, v35, vcc
    ds_write_b128 v45, v[96:99]
    s_waitcnt vmcnt(6)
    ds_write_b128 v46, v[48:51] offset:512
    ds_write_b128 v46, v[52:55] offset:1536
    ds_write_b128 v46, v[56:59] offset:2560
    ds_write_b128 v46, v[60:63] offset:3584
    s_waitcnt lgkmcnt(0)
    v_mov_b32 v64, 0
    v_mov_b32 v65, 0
    v_mov_b32 v66, 0
    v_mov_b32 v67, 0
    v_mov_b32 v68, 0
    v_mov_b32 v69, 0
    v_mov_b32 v70, 0
    v_mov_b32 v71, 0
    v_mov_b32 v72, 0
    v_mov_b32 v73, 0
    v_mov_b32 v74, 0
    v_mov_b32 v75, 0
    v_mov_b32 v76, 0
    v_mov_b32 v77, 0
    v_mov_b32 v78, 0
    v_mov_b32 v79, 0
    v_mov_b32 v80, 0
    v_mov_b32 v81, 0
    v_mov_b32 v82, 0
    v_mov_b32 v83, 0
    v_mov_b32 v84, 0
    v_mov_b32 v85, 0
    v_mov_b32 v86, 0
    v_mov_b32 v87, 0
    v_mov_b32 v88, 0
    v_mov_b32 v89, 0
    v_mov_b32 v90, 0
    v_mov_b32 v91, 0
    v_mov_b32 v92, 0
    v_mov_b32 v93, 0
    v_mov_b32 v94, 0
    v_mov_b32 v95, 0
    v_add_u32 v42, 384, v42
    ds_read_b128 a[32:35], v42 offset:64
    ds_read2_b32 a[0:1], v38 offset0:0 offset1:1
    ds_read2_b32 a[2:3], v38 offset0:2 offset1:3
    ds_read_b128 a[36:39], v42 offset:576
    ds_read2_b32 a[4:5], v38 offset0:128 offset1:129
    ds_read2_b32 a[6:7], v38 offset0:130 offset1:131
    ds_read_b128 a[40:43], v42 offset:1088
    ds_read2_b32 a[8:9], v39 offset0:0 offset1:1
    ds_read2_b32 a[10:11], v39 offset0:2 offset1:3
    ds_read_b128 a[44:47], v42 offset:1600
    ds_read2_b32 a[12:13], v39 offset0:128 offset1:129
    ds_read2_b32 a[14:15], v39 offset0:130 offset1:131
    ds_read_b128 a[48:51], v42 offset:2112
    ds_read2_b32 a[16:17], v40 offset0:0 offset1:1
    ds_read2_b32 a[18:19], v40 offset0:2 offset1:3
    ds_read_b128 a[52:55], v42 offset:2624
    ds_read2_b32 a[20:21], v40 offset0:128 offset1:129
    ds_read2_b32 a[22:23], v40 offset0:130 offset1:131
    ds_read_b128 a[56:59], v42 offset:3136
    ds_read2_b32 a[24:25], v41 offset0:0 offset1:1
    ds_read2_b32 a[26:27], v41 offset0:2 offset1:3
    ds_read_b128 a[60:63], v42 offset:3648
    ds_read2_b32 a[28:29], v41 offset0:128 offset1:129
    ds_read2_b32 a[30:31], v41 offset0:130 offset1:131
    v_mov_b32 v2, 163744
    s_mov_b32 s99, 0
PK_CW:
    s_sleep 2
    ds_read_b32 v3, v2
    s_add_u32 s99, s99, 1
    s_cmp_gt_u32 s99, 2097152
    s_waitcnt lgkmcnt(0)
    v_cmp_gt_u32 vcc, 4, v3
    s_cbranch_scc1 PK_CW_OK
    s_cbranch_vccnz PK_CW
PK_CW_OK:
    s_setprio 3
    s_mov_b32 s90, 0
    s_mov_b32 s92, 0
PK_CV_LOOP:
    s_waitcnt lgkmcnt(0)
    v_mfma_f32_16x16x32_bf16 v[64:67], a[0:3], a[32:35], v[64:67]
    ds_read_b128 a[96:99], v42 offset:0
    v_mfma_f32_16x16x32_bf16 v[68:71], a[0:3], a[36:39], v[68:71]
    ds_read2_b32 a[64:65], v38 offset0:16 offset1:17
    v_mfma_f32_16x16x32_bf16 v[68:71], a[4:7], a[32:35], v[68:71]
    ds_read2_b32 a[66:67], v38 offset0:18 offset1:19
    v_mfma_f32_16x16x32_bf16 v[72:75], a[0:3], a[40:43], v[72:75]
    ds_read_b128 a[100:103], v42 offset:512
    v_mfma_f32_16x16x32_bf16 v[72:75], a[4:7], a[36:39], v[72:75]
    ds_read2_b32 a[68:69], v38 offset0:144 offset1:145
    v_mfma_f32_16x16x32_bf16 v[72:75], a[8:11], a[32:35], v[72:75]
    ds_read2_b32 a[70:71], v38 offset0:146 offset1:147
    v_mfma_f32_16x16x32_bf16 v[76:79], a[0:3], a[44:47], v[76:79]
    ds_read_b128 a[104:107], v42 offset:1024
    v_mfma_f32_16x16x32_bf16 v[76:79], a[4:7], a[40:43], v[76:79]
    ds_read2_b32 a[72:73], v39 offset0:16 offset1:17
    v_mfma_f32_16x16x32_bf16 v[76:79], a[8:11], a[36:39], v[76:79]
    ds_read2_b32 a[74:75], v39 offset0:18 offset1:19
    v_mfma_f32_16x16x32_bf16 v[76:79], a[12:15], a[32:35], v[76:79]
    ds_read_b128 a[108:111], v42 offset:1536
    v_mfma_f32_16x16x32_bf16 v[80:83], a[0:3], a[48:51], v[80:83]
    ds_read2_b32 a[76:77], v39 offset0:144 offset1:145
    v_mfma_f32_16x16x32_bf16 v[80:83], a[4:7], a[44:47], v[80:83]
    ds_read2_b32 a[78:79], v39 offset0:146 offset1:147
    v_mfma_f32_16x16x32_bf16 v[80:83], a[8:11], a[40:43], v[80:83]
    ds_read_b128 a[112:115], v42 offset:2048
    v_mfma_f32_16x16x32_bf16 v[80:83], a[12:15], a[36:39], v[80:83]
    ds_read2_b32 a[80:81], v40 offset0:16 offset1:17
    v_mfma_f32_16x16x32_bf16 v[80:83], a[16:19], a[32:35], v[80:83]
    ds_read2_b32 a[82:83], v40 offset0:18 offset1:19
    v_mfma_f32_16x16x32_bf16 v[84:87], a[0:3], a[52:55], v[84:87]
    ds_read_b128 a[116:119], v42 offset:2560
    v_mfma_f32_16x16x32_bf16 v[84:87], a[4:7], a[48:51], v[84:87]
    ds_read2_b32 a[84:85], v40 offset0:144 offset1:145
    v_mfma_f32_16x16x32_bf16 v[84:87], a[8:11], a[44:47], v[84:87]
    ds_read2_b32 a[86:87], v40 offset0:146 offset1:147
    v_mfma_f32_16x16x32_bf16 v[84:87], a[12:15], a[40:43], v[84:87]
    ds_read_b128 a[120:123], v42 offset:3072
    v_mfma_f32_16x16x32_bf16 v[84:87], a[16:19], a[36:39], v[84:87]
    ds_read2_b32 a[88:89], v41 offset0:16 offset1:17
    v_mfma_f32_16x16x32_bf16 v[84:87], a[20:23], a[32:35], v[84:87]
    ds_read2_b32 a[90:91], v41 offset0:18 offset1:19
    v_mfma_f32_16x16x32_bf16 v[88:91], a[0:3], a[56:59], v[88:91]
    ds_read_b128 a[124:127], v42 offset:3584
    v_mfma_f32_16x16x32_bf16 v[88:91], a[4:7], a[52:55], v[88:91]
    ds_read2_b32 a[92:93], v41 offset0:144 offset1:145
    v_mfma_f32_16x16x32_bf16 v[88:91], a[8:11], a[48:51], v[88:91]
    ds_read2_b32 a[94:95], v41 offset0:146 offset1:147
    v_mfma_f32_16x16x32_bf16 v[88:91], a[12:15], a[44:47], v[88:91]
    v_mfma_f32_16x16x32_bf16 v[88:91], a[16:19], a[40:43], v[88:91]
    v_mfma_f32_16x16x32_bf16 v[88:91], a[20:23], a[36:39], v[88:91]
    v_mfma_f32_16x16x32_bf16 v[88:91], a[24:27], a[32:35], v[88:91]
    v_mfma_f32_16x16x32_bf16 v[92:95], a[0:3], a[60:63], v[92:95]
    v_mfma_f32_16x16x32_bf16 v[92:95], a[4:7], a[56:59], v[92:95]
    v_mfma_f32_16x16x32_bf16 v[92:95], a[8:11], a[52:55], v[92:95]
    v_mfma_f32_16x16x32_bf16 v[92:95], a[12:15], a[48:51], v[92:95]
    v_mfma_f32_16x16x32_bf16 v[92:95], a[16:19], a[44:47], v[92:95]
    v_mfma_f32_16x16x32_bf16 v[92:95], a[20:23], a[40:43], v[92:95]
    v_mfma_f32_16x16x32_bf16 v[92:95], a[24:27], a[36:39], v[92:95]
    v_mfma_f32_16x16x32_bf16 v[92:95], a[28:31], a[32:35], v[92:95]
    s_add_u32 s90, s90, 1
    s_cmp_eq_u32 s90, 4
    s_cbranch_scc1 PK_CV_LAST
    s_waitcnt lgkmcnt(0)
    v_add_u32 v38, 128, v38
    v_add_u32 v39, 128, v39
    v_add_u32 v40, 128, v40
    v_add_u32 v41, 128, v41
    v_subrev_u32 v42, 128, v42
    v_mfma_f32_16x16x32_bf16 v[64:67], a[64:67], a[96:99], v[64:67]
    ds_read_b128 a[32:35], v42 offset:64
    v_mfma_f32_16x16x32_bf16 v[68:71], a[64:67], a[100:103], v[68:71]
    ds_read2_b32 a[0:1], v38 offset0:0 offset1:1
    v_mfma_f32_16x16x32_bf16 v[68:71], a[68:71], a[96:99], v[68:71]
    ds_read2_b32 a[2:3], v38 offset0:2 offset1:3
    v_mfma_f32_16x16x32_bf16 v[72:75], a[64:67], a[104:107], v[72:75]
    ds_read_b128 a[36:39], v42 offset:576
    v_mfma_f32_16x16x32_bf16 v[72:75], a[68:71], a[100:103], v[72:75]
    ds_read2_b32 a[4:5], v38 offset0:128 offset1:129
    v_mfma_f32_16x16x32_bf16 v[72:75], a[72:75], a[96:99], v[72:75]
    ds_read2_b32 a[6:7], v38 offset0:130 offset1:131
    v_mfma_f32_16x16x32_bf16 v[76:79], a[64:67], a[108:111], v[76:79]
    ds_read_b128 a[40:43], v42 offset:1088
    v_mfma_f32_16x16x32_bf16 v[76:79], a[68:71], a[104:107], v[76:79]
    ds_read2_b32 a[8:9], v39 offset0:0 offset1:1
    v_mfma_f32_16x16x32_bf16 v[76:79], a[72:75], a[100:103], v[76:79]
    ds_read2_b32 a[10:11], v39 offset0:2 offset1:3
    v_mfma_f32_16x16x32_bf16 v[76:79], a[76:79], a[96:99], v[76:79]
    ds_read_b128 a[44:47], v42 offset:1600
    v_mfma_f32_16x16x32_bf16 v[80:83], a[64:67], a[112:115], v[80:83]
    ds_read2_b32 a[12:13], v39 offset0:128 offset1:129
    v_mfma_f32_16x16x32_bf16 v[80:83], a[68:71], a[108:111], v[80:83]
    ds_read2_b32 a[14:15], v39 offset0:130 offset1:131
    v_mfma_f32_16x16x32_bf16 v[80:83], a[72:75], a[104:107], v[80:83]
    ds_read_b128 a[48:51], v42 offset:2112
    v_mfma_f32_16x16x32_bf16 v[80:83], a[76:79], a[100:103], v[80:83]
    ds_read2_b32 a[16:17], v40 offset0:0 offset1:1
    v_mfma_f32_16x16x32_bf16 v[80:83], a[80:83], a[96:99], v[80:83]
    ds_read2_b32 a[18:19], v40 offset0:2 offset1:3
    v_mfma_f32_16x16x32_bf16 v[84:87], a[64:67], a[116:119], v[84:87]
    ds_read_b128 a[52:55], v42 offset:2624
    v_mfma_f32_16x16x32_bf16 v[84:87], a[68:71], a[112:115], v[84:87]
    ds_read2_b32 a[20:21], v40 offset0:128 offset1:129
    v_mfma_f32_16x16x32_bf16 v[84:87], a[72:75], a[108:111], v[84:87]
    ds_read2_b32 a[22:23], v40 offset0:130 offset1:131
    v_mfma_f32_16x16x32_bf16 v[84:87], a[76:79], a[104:107], v[84:87]
    ds_read_b128 a[56:59], v42 offset:3136
    v_mfma_f32_16x16x32_bf16 v[84:87], a[80:83], a[100:103], v[84:87]
    ds_read2_b32 a[24:25], v41 offset0:0 offset1:1
    v_mfma_f32_16x16x32_bf16 v[84:87], a[84:87], a[96:99], v[84:87]
    ds_read2_b32 a[26:27], v41 offset0:2 offset1:3
    v_mfma_f32_16x16x32_bf16 v[88:91], a[64:67], a[120:123], v[88:91]
    ds_read_b128 a[60:63], v42 offset:3648
    v_mfma_f32_16x16x32_bf16 v[88:91], a[68:71], a[116:119], v[88:91]
    ds_read2_b32 a[28:29], v41 offset0:128 offset1:129
    v_mfma_f32_16x16x32_bf16 v[88:91], a[72:75], a[112:115], v[88:91]
    ds_read2_b32 a[30:31], v41 offset0:130 offset1:131
    v_mfma_f32_16x16x32_bf16 v[88:91], a[76:79], a[108:111], v[88:91]
    v_mfma_f32_16x16x32_bf16 v[88:91], a[80:83], a[104:107], v[88:91]
    v_mfma_f32_16x16x32_bf16 v[88:91], a[84:87], a[100:103], v[88:91]
    v_mfma_f32_16x16x32_bf16 v[88:91], a[88:91], a[96:99], v[88:91]
    v_mfma_f32_16x16x32_bf16 v[92:95], a[64:67], a[124:127], v[92:95]
    v_mfma_f32_16x16x32_bf16 v[92:95], a[68:71], a[120:123], v[92:95]
    v_mfma_f32_16x16x32_bf16 v[92:95], a[72:75], a[116:119], v[92:95]
    v_mfma_f32_16x16x32_bf16 v[92:95], a[76:79], a[112:115], v[92:95]
    v_mfma_f32_16x16x32_bf16 v[92:95], a[80:83], a[108:111], v[92:95]
    v_mfma_f32_16x16x32_bf16 v[92:95], a[84:87], a[104:107], v[92:95]
    v_mfma_f32_16x16x32_bf16 v[92:95], a[88:91], a[100:103], v[92:95]
    v_mfma_f32_16x16x32_bf16 v[92:95], a[92:95], a[96:99], v[92:95]
    s_branch PK_CV_LOOP
PK_CV_LAST:
    s_waitcnt lgkmcnt(0)
    v_mfma_f32_16x16x32_bf16 v[64:67], a[64:67], a[96:99], v[64:67]
    ds_read_b64 v[100:101], v43 offset:0
    v_mfma_f32_16x16x32_bf16 v[68:71], a[64:67], a[100:103], v[68:71]
    ds_read_b64 v[102:103], v43 offset:512
    v_mfma_f32_16x16x32_bf16 v[68:71], a[68:71], a[96:99], v[68:71]
    ds_read_b64 v[104:105], v43 offset:1024
    v_mfma_f32_16x16x32_bf16 v[72:75], a[64:67], a[104:107], v[72:75]
    ds_read_b64 v[106:107], v43 offset:1536
    v_mfma_f32_16x16x32_bf16 v[72:75], a[68:71], a[100:103], v[72:75]
    ds_read_b64 v[108:109], v43 offset:2048
    v_mfma_f32_16x16x32_bf16 v[72:75], a[72:75], a[96:99], v[72:75]
    ds_read_b64 v[110:111], v43 offset:2560
    v_mfma_f32_16x16x32_bf16 v[76:79], a[64:67], a[108:111], v[76:79]
    ds_read_b64 v[112:113], v43 offset:3072
    v_mfma_f32_16x16x32_bf16 v[76:79], a[68:71], a[104:107], v[76:79]
    ds_read_b64 v[114:115], v43 offset:3584
    v_mfma_f32_16x16x32_bf16 v[76:79], a[72:75], a[100:103], v[76:79]
    v_mfma_f32_16x16x32_bf16 v[76:79], a[76:79], a[96:99], v[76:79]
    v_mfma_f32_16x16x32_bf16 v[80:83], a[64:67], a[112:115], v[80:83]
    v_mfma_f32_16x16x32_bf16 v[80:83], a[68:71], a[108:111], v[80:83]
    v_mfma_f32_16x16x32_bf16 v[80:83], a[72:75], a[104:107], v[80:83]
    v_mfma_f32_16x16x32_bf16 v[80:83], a[76:79], a[100:103], v[80:83]
    s_waitcnt lgkmcnt(0)
    v_mfma_f32_16x16x32_bf16 v[80:83], a[80:83], a[96:99], v[80:83]
    v_and_b32 v116, 0xffff0000, v101
    v_lshlrev_b32 v117, 16, v101
    v_mfma_f32_16x16x32_bf16 v[84:87], a[64:67], a[116:119], v[84:87]
    v_and_b32 v118, 0xffff0000, v100
    v_lshlrev_b32 v119, 16, v100
    v_mfma_f32_16x16x32_bf16 v[84:87], a[68:71], a[112:115], v[84:87]
    v_fmac_f32 v64, v116, v37
    v_fmac_f32 v65, v117, v37
    v_mfma_f32_16x16x32_bf16 v[84:87], a[72:75], a[108:111], v[84:87]
    v_fmac_f32 v66, v118, v37
    v_fmac_f32 v67, v119, v37
    v_mfma_f32_16x16x32_bf16 v[84:87], a[76:79], a[104:107], v[84:87]
    v_cvt_pk_bf16_f32 v100, v64, v65
    v_cvt_pk_bf16_f32 v101, v66, v67
    v_mfma_f32_16x16x32_bf16 v[84:87], a[80:83], a[100:103], v[84:87]
    buffer_store_dwordx2 v[100:101], v44, s[76:79], 0 offen offset:0 sc1
    v_and_b32 v116, 0xffff0000, v103
    v_mfma_f32_16x16x32_bf16 v[84:87], a[84:87], a[96:99], v[84:87]
    v_lshlrev_b32 v117, 16, v103
    v_and_b32 v118, 0xffff0000, v102
    v_mfma_f32_16x16x32_bf16 v[88:91], a[64:67], a[120:123], v[88:91]
    v_lshlrev_b32 v119, 16, v102
    v_fmac_f32 v68, v116, v37
    v_mfma_f32_16x16x32_bf16 v[88:91], a[68:71], a[116:119], v[88:91]
    v_fmac_f32 v69, v117, v37
    v_fmac_f32 v70, v118, v37
    v_mfma_f32_16x16x32_bf16 v[88:91], a[72:75], a[112:115], v[88:91]
    v_fmac_f32 v71, v119, v37
    v_cvt_pk_bf16_f32 v102, v68, v69
    v_mfma_f32_16x16x32_bf16 v[88:91], a[76:79], a[108:111], v[88:91]
    v_cvt_pk_bf16_f32 v103, v70, v71
    buffer_store_dwordx2 v[102:103], v44, s[76:79], 0 offen offset:512 sc1
    v_mfma_f32_16x16x32_bf16 v[88:91], a[80:83], a[104:107], v[88:91]
    v_and_b32 v116, 0xffff0000, v105
    v_lshlrev_b32 v117, 16, v105
    v_and_b32 v118, 0xffff0000, v104
    v_mfma_f32_16x16x32_bf16 v[88:91], a[84:87], a[100:103], v[88:91]
    v_lshlrev_b32 v119, 16, v104
    v_fmac_f32 v72, v116, v37
    v_fmac_f32 v73, v117, v37
    v_mfma_f32_16x16x32_bf16 v[88:91], a[88:91], a[96:99], v[88:91]
    v_fmac_f32 v74, v118, v37
    v_fmac_f32 v75, v119, v37
    v_cvt_pk_bf16_f32 v104, v72, v73
    v_mfma_f32_16x16x32_bf16 v[92:95], a[64:67], a[124:127], v[92:95]
    v_cvt_pk_bf16_f32 v105, v74, v75
    buffer_store_dwordx2 v[104:105], v44, s[76:79], 0 offen offset:1024 sc1
    v_and_b32 v116, 0xffff0000, v107
    v_mfma_f32_16x16x32_bf16 v[92:95], a[68:71], a[120:123], v[92:95]
    v_lshlrev_b32 v117, 16, v107
    v_and_b32 v118, 0xffff0000, v106
    v_lshlrev_b32 v119, 16, v106
    v_mfma_f32_16x16x32_bf16 v[92:95], a[72:75], a[116:119], v[92:95]
    v_fmac_f32 v76, v116, v37
    v_fmac_f32 v77, v117, v37
    v_fmac_f32 v78, v118, v37
    v_mfma_f32_16x16x32_bf16 v[92:95], a[76:79], a[112:115], v[92:95]
    v_fmac_f32 v79, v119, v37
    v_cvt_pk_bf16_f32 v106, v76, v77
    v_cvt_pk_bf16_f32 v107, v78, v79
    v_mfma_f32_16x16x32_bf16 v[92:95], a[80:83], a[108:111], v[92:95]
    buffer_store_dwordx2 v[106:107], v44, s[76:79], 0 offen offset:1536 sc1
    v_and_b32 v116, 0xffff0000, v109
    v_lshlrev_b32 v117, 16, v109
    v_mfma_f32_16x16x32_bf16 v[92:95], a[84:87], a[104:107], v[92:95]
    v_and_b32 v118, 0xffff0000, v108
    v_lshlrev_b32 v119, 16, v108
    v_fmac_f32 v80, v116, v37
    v_mfma_f32_16x16x32_bf16 v[92:95], a[88:91], a[100:103], v[92:95]
    v_fmac_f32 v81, v117, v37
    v_fmac_f32 v82, v118, v37
    v_fmac_f32 v83, v119, v37
    v_mfma_f32_16x16x32_bf16 v[92:95], a[92:95], a[96:99], v[92:95]
    v_cvt_pk_bf16_f32 v108, v80, v81
    v_cvt_pk_bf16_f32 v109, v82, v83
    buffer_store_dwordx2 v[108:109], v44, s[76:79], 0 offen offset:2048 sc1
    v_and_b32 v116, 0xffff0000, v111
    v_lshlrev_b32 v117, 16, v111
    v_and_b32 v118, 0xffff0000, v110
    v_lshlrev_b32 v119, 16, v110
    v_fmac_f32 v84, v116, v37
    v_fmac_f32 v85, v117, v37
    v_fmac_f32 v86, v118, v37
    v_fmac_f32 v87, v119, v37
    v_cvt_pk_bf16_f32 v110, v84, v85
    v_cvt_pk_bf16_f32 v111, v86, v87
    buffer_store_dwordx2 v[110:111], v44, s[76:79], 0 offen offset:2560 sc1
    v_and_b32 v116, 0xffff0000, v113
    v_lshlrev_b32 v117, 16, v113
    v_and_b32 v118, 0xffff0000, v112
    v_lshlrev_b32 v119, 16, v112
    v_fmac_f32 v88, v116, v37
    v_fmac_f32 v89, v117, v37
    v_fmac_f32 v90, v118, v37
    v_fmac_f32 v91, v119, v37
    v_cvt_pk_bf16_f32 v112, v88, v89
    v_cvt_pk_bf16_f32 v113, v90, v91
    buffer_store_dwordx2 v[112:113], v44, s[76:79], 0 offen offset:3072 sc1
    v_and_b32 v116, 0xffff0000, v115
    v_lshlrev_b32 v117, 16, v115
    v_and_b32 v118, 0xffff0000, v114
    v_lshlrev_b32 v119, 16, v114
    v_fmac_f32 v92, v116, v37
    v_fmac_f32 v93, v117, v37
    v_fmac_f32 v94, v118, v37
    v_fmac_f32 v95, v119, v37
    v_cvt_pk_bf16_f32 v114, v92, v93
    v_cvt_pk_bf16_f32 v115, v94, v95
    buffer_store_dwordx2 v[114:115], v44, s[76:79], 0 offen offset:3584 sc1
    s_lshl_b32 s90, s94, 4
    s_add_u32 s90, s90, 10047488
    s_waitcnt vmcnt(0)
    v_mov_b32 v2, s80
    v_mov_b32 v3, s90
    s_mov_b64 exec, 1
    buffer_store_dword v2, v3, s[76:79], 0 offen sc1
    s_mov_b64 exec, -1
    s_branch PK_PCOMP
PK_NOCONV:
    s_setprio 0
    v_mov_b32 v2, 163752
    s_mov_b32 s99, 0
PK_NCW:
    s_sleep 16
    ds_read_b32 v3, v2
    s_add_u32 s99, s99, 1
    s_cmp_gt_u32 s99, 2097152
    s_waitcnt lgkmcnt(0)
    v_cmp_gt_u32 vcc, 4, v3
    s_cbranch_scc1 PK_NCW_OK
    s_cbranch_vccnz PK_NCW
PK_NCW_OK:
    s_setprio 3
    buffer_load_dwordx2 v[16:17], v5, s[32:35], 0 offen offset:0
    buffer_load_dwordx2 v[18:19], v5, s[32:35], 0 offen offset:32
    buffer_load_dwordx2 v[20:21], v5, s[32:35], 0 offen offset:64
    buffer_load_dwordx2 v[22:23], v5, s[32:35], 0 offen offset:96
    buffer_load_dwordx2 v[24:25], v5, s[32:35], 0 offen offset:128
    buffer_load_ushort v124, v126, s[68:71], 0 offen
PK_PCOMP:
    s_setprio 0
    v_mov_b32 v2, 163748
    s_mov_b32 s99, 0
PK_YW:
    s_sleep 4
    ds_read_b32 v3, v2
    s_add_u32 s99, s99, 1
    s_cmp_gt_u32 s99, 2097152
    s_waitcnt lgkmcnt(0)
    v_cmp_gt_u32 vcc, 654992, v3
    s_cbranch_scc1 PK_YW_OK
    s_cbranch_vccnz PK_YW
PK_YW_OK:
    s_setprio 3
    s_mov_b32 s99, 0
PK_SPIN_Y:
    buffer_load_dword v26, v7, s[76:79], 0 offen sc1
    buffer_load_dword v27, v8, s[76:79], 0 offen sc1
    s_add_u32 s99, s99, 1
    s_waitcnt vmcnt(0)
    v_cmp_ne_u32 vcc, s80, v26
    v_cmp_ne_u32 s[28:29], s80, v27
    s_or_b64 vcc, vcc, s[28:29]
    s_cmp_gt_u32 s99, 20000
    s_cbranch_scc1 PK_SPIN_Y_OK
    s_cbranch_vccnz PK_SPIN_Y
PK_SPIN_Y_OK:
    buffer_load_dwordx4 v[28:31], v9, s[76:79], 0 offen sc1
    buffer_load_dwordx4 v[32:35], v10, s[76:79], 0 offen sc1
    buffer_load_dwordx4 v[36:39], v11, s[76:79], 0 offen sc1
    buffer_load_dwordx2 v[40:41], v6, s[76:79], 0 offen sc1
    v_lshlrev_b32 v44, 16, v16
    v_and_b32 v45, 0xffff0000, v16
    v_lshlrev_b32 v46, 16, v17
    v_and_b32 v47, 0xffff0000, v17
    v_lshlrev_b32 v48, 16, v18
    v_and_b32 v49, 0xffff0000, v18
    v_lshlrev_b32 v50, 16, v19
    v_and_b32 v51, 0xffff0000, v19
    v_lshlrev_b32 v52, 16, v20
    v_and_b32 v53, 0xffff0000, v20
    v_lshlrev_b32 v54, 16, v21
    v_and_b32 v55, 0xffff0000, v21
    v_lshlrev_b32 v56, 16, v22
    v_and_b32 v57, 0xffff0000, v22
    v_lshlrev_b32 v58, 16, v23
    v_and_b32 v59, 0xffff0000, v23
    v_lshlrev_b32 v60, 16, v24
    v_and_b32 v61, 0xffff0000, v24
    v_lshlrev_b32 v62, 16, v25
    v_and_b32 v63, 0xffff0000, v25
    s_waitcnt vmcnt(1)
    ds_write_b128 v12, v[28:31]
    ds_write_b128 v12, v[32:35] offset:1024
    s_mov_b32 exec_hi, 0
    ds_write_b128 v12, v[36:39] offset:2048
    s_mov_b64 exec, -1
    s_waitcnt vmcnt(0) lgkmcnt(0)
    ds_read_b64_tr_b16 v[94:95], v13 offset:0
    ds_read_b64_tr_b16 v[96:97], v13 offset:512
    ds_read_b64_tr_b16 v[98:99], v13 offset:1024
    ds_read_b64_tr_b16 v[100:101], v13 offset:1536
    ds_read_b64_tr_b16 v[102:103], v13 offset:2048
    v_mul_f32 v42, v40, v41
    v_mul_f32 v43, v40, v41
    v_mov_b32 v40, v41
    v_pk_fma_f32 v[64:65], v[44:45], v[40:41], v[42:43] neg_lo:[0,0,1] neg_hi:[0,0,1]
    v_pk_fma_f32 v[66:67], v[46:47], v[40:41], v[42:43] neg_lo:[0,0,1] neg_hi:[0,0,1]
    v_pk_fma_f32 v[68:69], v[48:49], v[40:41], v[42:43] neg_lo:[0,0,1] neg_hi:[0,0,1]
    v_pk_fma_f32 v[70:71], v[50:51], v[40:41], v[42:43] neg_lo:[0,0,1] neg_hi:[0,0,1]
    v_pk_fma_f32 v[72:73], v[52:53], v[40:41], v[42:43] neg_lo:[0,0,1] neg_hi:[0,0,1]
    v_pk_fma_f32 v[74:75], v[54:55], v[40:41], v[42:43] neg_lo:[0,0,1] neg_hi:[0,0,1]
    v_pk_fma_f32 v[76:77], v[56:57], v[40:41], v[42:43] neg_lo:[0,0,1] neg_hi:[0,0,1]
    v_pk_fma_f32 v[78:79], v[58:59], v[40:41], v[42:43] neg_lo:[0,0,1] neg_hi:[0,0,1]
    v_pk_fma_f32 v[80:81], v[60:61], v[40:41], v[42:43] neg_lo:[0,0,1] neg_hi:[0,0,1]
    v_pk_fma_f32 v[82:83], v[62:63], v[40:41], v[42:43] neg_lo:[0,0,1] neg_hi:[0,0,1]
    v_cvt_pk_bf16_f32 v84, v64, v65
    v_cvt_pk_bf16_f32 v85, v66, v67
    v_cvt_pk_bf16_f32 v86, v68, v69
    v_cvt_pk_bf16_f32 v87, v70, v71
    v_cvt_pk_bf16_f32 v88, v72, v73
    v_cvt_pk_bf16_f32 v89, v74, v75
    v_cvt_pk_bf16_f32 v90, v76, v77
    v_cvt_pk_bf16_f32 v91, v78, v79
    v_cvt_pk_bf16_f32 v92, v80, v81
    v_cvt_pk_bf16_f32 v93, v82, v83
    v_lshlrev_b32 v64, 16, v84
    v_and_b32 v65, 0xffff0000, v84
    v_lshlrev_b32 v66, 16, v85
    v_and_b32 v67, 0xffff0000, v85
    v_lshlrev_b32 v68, 16, v86
    v_and_b32 v69, 0xffff0000, v86
    v_lshlrev_b32 v70, 16, v87
    v_and_b32 v71, 0xffff0000, v87
    v_lshlrev_b32 v72, 16, v88
    v_and_b32 v73, 0xffff0000, v88
    v_lshlrev_b32 v74, 16, v89
    v_and_b32 v75, 0xffff0000, v89
    v_lshlrev_b32 v76, 16, v90
    v_and_b32 v77, 0xffff0000, v90
    v_lshlrev_b32 v78, 16, v91
    v_and_b32 v79, 0xffff0000, v91
    v_lshlrev_b32 v80, 16, v92
    v_and_b32 v81, 0xffff0000, v92
    v_lshlrev_b32 v82, 16, v93
    v_and_b32 v83, 0xffff0000, v93
    s_waitcnt lgkmcnt(0)
    v_lshlrev_b32 v104, 16, v94
    v_and_b32 v105, 0xffff0000, v94
    v_lshlrev_b32 v106, 16, v95
    v_and_b32 v107, 0xffff0000, v95
    v_lshlrev_b32 v108, 16, v96
    v_and_b32 v109, 0xffff0000, v96
    v_lshlrev_b32 v110, 16, v97
    v_and_b32 v111, 0xffff0000, v97
    v_lshlrev_b32 v112, 16, v98
    v_and_b32 v113, 0xffff0000, v98
    v_lshlrev_b32 v114, 16, v99
    v_and_b32 v115, 0xffff0000, v99
    v_lshlrev_b32 v116, 16, v100
    v_and_b32 v117, 0xffff0000, v100
    v_lshlrev_b32 v118, 16, v101
    v_and_b32 v119, 0xffff0000, v101
    v_lshlrev_b32 v120, 16, v102
    v_and_b32 v121, 0xffff0000, v102
    v_lshlrev_b32 v122, 16, v103
    v_and_b32 v123, 0xffff0000, v103
    v_pk_fma_f32 v[64:65], v[64:65], v[104:105], v[44:45]
    v_pk_fma_f32 v[66:67], v[66:67], v[106:107], v[46:47]
    v_pk_fma_f32 v[68:69], v[68:69], v[108:109], v[48:49]
    v_pk_fma_f32 v[70:71], v[70:71], v[110:111], v[50:51]
    v_pk_fma_f32 v[72:73], v[72:73], v[112:113], v[52:53]
    v_pk_fma_f32 v[74:75], v[74:75], v[114:115], v[54:55]
    v_pk_fma_f32 v[76:77], v[76:77], v[116:117], v[56:57]
    v_pk_fma_f32 v[78:79], v[78:79], v[118:119], v[58:59]
    v_pk_fma_f32 v[80:81], v[80:81], v[120:121], v[60:61]
    v_pk_fma_f32 v[82:83], v[82:83], v[122:123], v[62:63]
    v_cvt_pk_bf16_f32 v84, v64, v65
    v_cvt_pk_bf16_f32 v85, v66, v67
    ds_write_b64 v13, v[84:85] offset:0
    v_cvt_pk_bf16_f32 v86, v68, v69
    v_cvt_pk_bf16_f32 v87, v70, v71
    ds_write_b64 v13, v[86:87] offset:512
    v_cvt_pk_bf16_f32 v88, v72, v73
    v_cvt_pk_bf16_f32 v89, v74, v75
    ds_write_b64 v13, v[88:89] offset:1024
    v_cvt_pk_bf16_f32 v90, v76, v77
    v_cvt_pk_bf16_f32 v91, v78, v79
    v_cvt_pk_bf16_f32 v92, v80, v81
    v_cvt_pk_bf16_f32 v93, v82, v83
    v_mov_b32 v2, 163772
    v_mov_b32 v3, 1
    s_waitcnt lgkmcnt(0)
    s_mov_b64 exec, 1
    ds_add_u32 v2, v3
    s_mov_b64 exec, -1
    v_lshlrev_b32 v64, 16, v90
    v_and_b32 v65, 0xffff0000, v90
    v_lshlrev_b32 v66, 16, v91
    v_and_b32 v67, 0xffff0000, v91
    v_lshlrev_b32 v68, 16, v92
    v_and_b32 v69, 0xffff0000, v92
    v_lshlrev_b32 v70, 16, v93
    v_and_b32 v71, 0xffff0000, v93
    v_lshlrev_b32 v125, 16, v124
    v_lshlrev_b32 v124, 16, v124
    s_mul_i32 s90, s3, 5120
    v_lshl_add_u32 v12, v1, 4, s90
    v_add_u32 v13, 57344, v12
    v_mov_b32 v2, 163756
    s_mov_b32 s99, 0
PK_HFW:
    ds_read_b32 v3, v2
    s_add_u32 s99, s99, 1
    s_cmp_gt_u32 s99, 2097152
    s_waitcnt lgkmcnt(0)
    v_cmp_gt_u32 vcc, 4, v3
    s_cbranch_scc1 PK_HFW_OK
    s_cbranch_vccnz PK_HFW
PK_HFW_OK:
    ds_read_b128 v[16:19], v12 offset:3072
    ds_read_b128 v[20:23], v12 offset:4096
    ds_read_b128 v[24:27], v12 offset:31744
    ds_read_b128 v[28:31], v12 offset:32768
    ds_read_b128 v[32:35], v13 offset:3072
    ds_read_b128 v[36:39], v13 offset:4096
    ds_read_b128 v[40:43], v13 offset:31744
    ds_read_b128 v[44:47], v13 offset:32768
    s_waitcnt lgkmcnt(6)
    v_pk_add_f32 v[100:101], v[124:125], v[16:17]
    v_pk_add_f32 v[102:103], v[124:125], v[18:19]
    v_pk_add_f32 v[104:105], v[124:125], v[20:21]
    v_pk_add_f32 v[106:107], v[124:125], v[22:23]
    s_waitcnt lgkmcnt(4)
    v_pk_add_f32 v[100:101], v[100:101], v[24:25]
    v_pk_add_f32 v[102:103], v[102:103], v[26:27]
    v_pk_add_f32 v[104:105], v[104:105], v[28:29]
    v_pk_add_f32 v[106:107], v[106:107], v[30:31]
    s_waitcnt lgkmcnt(2)
    v_pk_add_f32 v[100:101], v[100:101], v[32:33]
    v_pk_add_f32 v[102:103], v[102:103], v[34:35]
    v_pk_add_f32 v[104:105], v[104:105], v[36:37]
    v_pk_add_f32 v[106:107], v[106:107], v[38:39]
    s_waitcnt lgkmcnt(0)
    v_pk_add_f32 v[100:101], v[100:101], v[40:41]
    v_pk_add_f32 v[102:103], v[102:103], v[42:43]
    v_pk_add_f32 v[104:105], v[104:105], v[44:45]
    v_pk_add_f32 v[106:107], v[106:107], v[46:47]
    v_cvt_pk_bf16_f32 v16, v100, v101
    v_cvt_pk_bf16_f32 v17, v102, v103
    v_cvt_pk_bf16_f32 v18, v104, v105
    v_cvt_pk_bf16_f32 v19, v106, v107
    v_lshlrev_b32 v100, 16, v16
    v_and_b32 v101, 0xffff0000, v16
    v_lshlrev_b32 v102, 16, v17
    v_and_b32 v103, 0xffff0000, v17
    v_lshlrev_b32 v104, 16, v18
    v_and_b32 v105, 0xffff0000, v18
    v_lshlrev_b32 v106, 16, v19
    v_and_b32 v107, 0xffff0000, v19
    v_pk_add_f32 v[100:101], v[100:101], v[64:65]
    v_pk_add_f32 v[102:103], v[102:103], v[66:67]
    v_pk_add_f32 v[104:105], v[104:105], v[68:69]
    v_pk_add_f32 v[106:107], v[106:107], v[70:71]
    v_cvt_pk_bf16_f32 v16, v100, v101
    v_cvt_pk_bf16_f32 v17, v102, v103
    buffer_store_dwordx2 v[16:17], v5, s[72:75], 0 offen offset:96
    v_cvt_pk_bf16_f32 v18, v104, v105
    v_cvt_pk_bf16_f32 v19, v106, v107
    buffer_store_dwordx2 v[18:19], v5, s[72:75], 0 offen offset:128
PK_END:
    s_endpgm
.section .rodata,"a"
.p2align 6
.amdhsa_kernel parallel_sum__ssm_conv_h3__mixer_token_mlp__prompt_kernel
  .amdhsa_next_free_vgpr 256
  .amdhsa_next_free_sgpr 102
  .amdhsa_accum_offset 128
  .amdhsa_group_segment_fixed_size 0
  .amdhsa_kernarg_size 112
  .amdhsa_user_sgpr_count 2
  .amdhsa_user_sgpr_kernarg_segment_ptr 1
  .amdhsa_system_sgpr_workgroup_id_x 1
  .amdhsa_float_denorm_mode_32 3
.end_amdhsa_kernel
```
